```python
import torch

def _softmax(x, axis=-1):
    return torch.softmax(x, dim=axis)
def _gelu(x):
    return torch.nn.functional.gelu(x, approximate="tanh")
def _silu(x):
    return torch.nn.functional.silu(x)
def _sigmoid(x):
    return torch.sigmoid(x)
def _layernorm(x, axis=-1, eps=1e-5):
    m = x.mean(dim=axis, keepdim=True)
    v = x.var(dim=axis, keepdim=True, unbiased=False)
    return (x - m) / torch.sqrt(v + eps)
def _scatter_add(tgt, idx, src, axis=0):
    return tgt.clone().index_add_(axis, idx, src)
def _segment_sum(src, seg, n):
    out = torch.zeros((n,) + src.shape[1:], dtype=src.dtype)
    return out.index_add_(0, seg, src)
def _pad(x, pw):
    flat = tuple(v for pair in reversed(pw) for v in pair)
    return torch.nn.functional.pad(x, flat)

kernel_name = 'gated_mix__ssm_conv_s5__dense_activation_mish__prompt'

def setup_inputs():

    _w = (lambda a: (lambda t: t.to(torch.bfloat16) if t.is_floating_point() else t)(torch.as_tensor(a)))
    def _A_setup():
        B, S, D = 1, 2048, 512
        P = D
        Lambda_re = -0.5 * (lambda _x: torch.exp(torch.as_tensor(_x)))((lambda *s: torch.randn(*s, dtype=torch.bfloat16) * 0.2)(P))
        Lambda_im = (lambda *s: torch.randn(*s, dtype=torch.bfloat16) * 0.2)(P) * 1.0
        B_re = (lambda *s: torch.randn(*s, dtype=torch.bfloat16) * 0.2)(P, D) * (D ** -0.5)
        B_im = (lambda *s: torch.randn(*s, dtype=torch.bfloat16) * 0.2)(P, D) * (D ** -0.5)
        C_re = (lambda *s: torch.randn(*s, dtype=torch.bfloat16) * 0.2)(D, P) * (P ** -0.5)
        C_im = (lambda *s: torch.randn(*s, dtype=torch.bfloat16) * 0.2)(D, P) * (P ** -0.5)
        log_dt = (lambda *s: torch.randn(*s, dtype=torch.bfloat16) * 0.2)(P) * 0.3 - 2.0
        Dskip = (lambda *s: torch.randn(*s, dtype=torch.bfloat16) * 0.05)(D)
        return {
            "x": _w((lambda *s: torch.randn(*s, dtype=torch.bfloat16) * 0.05)(B, S, D)),
            "Lambda_re": _w(Lambda_re),
            "Lambda_im": _w(Lambda_im),
            "B_re": _w(B_re),
            "B_im": _w(B_im),
            "C_re": _w(C_re),
            "C_im": _w(C_im),
            "log_dt": _w(log_dt),
            "Dskip": _w(Dskip),
        }
    _A_in = _A_setup()

    def _B_setup():
        B, S, D, F = 1, 2048, 512, 1792
        return {
            "x": _w((lambda *s: torch.randn(*s, dtype=torch.bfloat16) * 0.05)(B, S, D)),
            "w1": _w((lambda *s: torch.randn(*s, dtype=torch.bfloat16) * 3.2)(D, F) * (D ** -0.5)),
            "b1": _w((lambda *s: torch.randn(*s, dtype=torch.bfloat16) * 0.05)(F)),
            "w2": _w((lambda *s: torch.randn(*s, dtype=torch.bfloat16) * 0.05)(F, D) * (F ** -0.5)),
        }
    _B_in = _B_setup()

    return {
        "A_x": _A_in["x"],
        "A_Lambda_re": _A_in["Lambda_re"],
        "A_Lambda_im": _A_in["Lambda_im"],
        "A_B_re": _A_in["B_re"],
        "A_B_im": _A_in["B_im"],
        "A_C_re": _A_in["C_re"],
        "A_C_im": _A_in["C_im"],
        "A_log_dt": _A_in["log_dt"],
        "A_Dskip": _A_in["Dskip"],
        "B_x": _B_in["x"],
        "B_w1": _B_in["w1"],
        "B_b1": _B_in["b1"],
        "B_w2": _B_in["w2"],
        "gate_w": _w((lambda *s: torch.randn(*s, dtype=torch.bfloat16) * 0.05)(512) * 16.0),
    }

def reference(A_x, A_Lambda_re, A_Lambda_im, A_B_re, A_B_im, A_C_re, A_C_im, A_log_dt, A_Dskip, B_x, B_w1, B_b1, B_w2, gate_w):
    def _A_ref(x, Lambda_re, Lambda_im, B_re, B_im, C_re, C_im, log_dt, Dskip):
        Bsz, L, H = x.shape
        Lam = Lambda_re + 1j * Lambda_im
        Bmat = B_re + 1j * B_im
        Cmat = C_re + 1j * C_im
        dt = torch.exp(log_dt)
        Lam_bar = torch.exp(dt * Lam)
        B_bar = ((Lam_bar - 1.0) / Lam)[:, None] * Bmat
        Bu = torch.einsum("bld,pd->blp", x + 0j, B_bar)
        h = torch.zeros_like(Bu[:, 0, :])
        hs = []
        for t in range(L):
            h = Lam_bar[None, :] * h + Bu[:, t, :]
            hs.append(h)
        hseq = torch.stack(hs, 1)
        y = 2.0 * torch.einsum("blp,dp->bld", hseq, Cmat).real + x * Dskip[None, None, :]
        return y

    def _B_ref(x, w1, b1, w2):
        h = torch.einsum("bsd,df->bsf", x, w1) + b1
        sp = torch.log1p(torch.exp(-torch.abs(h))) + torch.where(h > 0, h, torch.zeros_like(h))
        act = h * torch.tanh(sp)
        return torch.einsum("bsf,fd->bsd", act, w2)

    x = A_x
    g = _sigmoid((x * gate_w).sum(-1, keepdims=True))
    a = _A_ref(x, A_Lambda_re, A_Lambda_im, A_B_re, A_B_im, A_C_re, A_C_im, A_log_dt, A_Dskip)
    b = _B_ref(x, B_w1, B_b1, B_w2)
    return g * a + (1 - g) * b
```

```asm
; @launch grid=(256,1,1) block=(256,1,1) lds=149760
.amdgcn_target "amdgcn-amd-amdhsa--gfx950"
.text
.globl gated_mix__ssm_conv_s5__dense_activation_mish__prompt_kernel
.p2align 8
.type gated_mix__ssm_conv_s5__dense_activation_mish__prompt_kernel,@function
gated_mix__ssm_conv_s5__dense_activation_mish__prompt_kernel:
    s_cmp_ge_u32 s2, 256
    s_cbranch_scc1 L_end
    s_load_dwordx16 s[8:23], s[0:1], 0
    s_load_dwordx16 s[24:39], s[0:1], 64
    s_load_dwordx2 s[40:41], s[0:1], 128
    v_and_b32 v1, 63, v0
    v_lshrrev_b32 v2, 6, v0
    s_nop 0
    v_readfirstlane_b32 s5, v2
    s_and_b32 s86, s2, 7
    s_lshr_b32 s87, s2, 3
    s_lshr_b32 s88, s87, 4
    s_lshl_b32 s3, s86, 1
    s_add_u32 s3, s3, s88
    s_and_b32 s4, s87, 15
    s_mov_b32 s95, s3
    s_lshr_b32 s96, s4, 3
    s_and_b32 s97, s4, 7
    s_lshr_b32 s6, s5, 1
    s_and_b32 s7, s5, 1
    s_lshl_b32 s86, s4, 7
    s_mul_i32 s87, s4, 96
    s_add_u32 s87, s87, 256
    s_cmp_lt_u32 s4, 8
    s_cselect_b32 s94, s86, s87
    v_lshrrev_b32 v2, 3, v1
    v_lshrrev_b32 v3, 4, v1
    v_and_b32 v4, 7, v1
    v_xor_b32 v5, v4, v3
    v_xor_b32 v6, 4, v5
    v_lshlrev_b32 v5, 4, v5
    v_lshlrev_b32 v6, 4, v6
    v_lshlrev_b32 v7, 10, v2
    v_add_u32 v164, v7, v5
    v_add_u32 v165, v7, v6
    v_lshrrev_b32 v7, 2, v2
    v_lshlrev_b32 v7, 5, v7
    v_and_b32 v8, 1, v2
    v_lshl_add_u32 v7, v8, 3, v7
    v_bfe_u32 v8, v2, 1, 1
    v_add_u32 v7, v7, v8
    v_lshlrev_b32 v7, 10, v7
    v_add_u32 v162, v7, v5
    v_add_u32 v163, v7, v6
    v_bfe_u32 v7, v1, 2, 2
    v_xor_b32 v8, v7, v3
    v_mul_u32_u24 v9, 3584, v3
    v_lshl_add_u32 v9, v8, 6, v9
    v_and_b32 v10, 3, v1
    v_lshl_add_u32 v166, v10, 4, v9
    s_cmp_lt_u32 s4, 8
    s_cselect_b32 s86, 4, 3
    v_cmp_eq_u32 vcc, s86, v8
    v_mov_b32 v9, 0x40000000
    s_nop 0
    v_cndmask_b32 v166, v166, v9, vcc
    s_lshl_b32 s86, s3, 7
    s_lshl_b32 s87, s6, 6
    s_add_u32 s86, s86, s87
    s_lshl_b32 s87, s7, 4
    s_add_u32 s86, s86, s87
    s_lshl_b32 s80, s86, 10
    s_lshl_b32 s86, s4, 5
    s_lshl_b32 s87, s6, 4
    s_add_u32 s86, s86, s87
    s_lshl_b32 s81, s86, 10
    s_mul_i32 s86, s5, 57344
    s_lshl_b32 s87, s94, 1
    s_add_u32 s82, s86, s87
    s_lshl_b32 s83, s5, 12
    s_lshl_b32 s84, s6, 12
    s_lshl_b32 s86, s7, 11
    s_add_u32 s84, s84, s86
    s_add_u32 s84, s84, 49152
    s_add_u32 s85, s83, 73728
    s_or_b32 s86, s2, s5
    s_waitcnt lgkmcnt(0)
    s_cmp_eq_u32 s86, 0
    s_cselect_b32 s1, 1, 0
    s_mov_b32 s44, s8
    s_and_b32 s45, s9, 0xffff
    s_mov_b32 s46, 0x200000
    s_mov_b32 s47, 0x20000
    s_cmp_eq_u32 s7, 0
    s_cselect_b32 s48, s14, s16
    s_cselect_b32 s49, s15, s17
    s_and_b32 s49, s49, 0xffff
    s_mov_b32 s50, 524288
    s_mov_b32 s51, 0x20000
    s_mov_b32 s52, s28
    s_and_b32 s53, s29, 0xffff
    s_mov_b32 s54, 0x1c0000
    s_mov_b32 s55, 0x20000
    s_add_u32 m0, s83, 0
    s_add_u32 s2, s80, 0
    buffer_load_dwordx4 v162, s[44:47], s2 offen offset:0 lds
    s_add_u32 s0, s80, 1024
    buffer_load_dwordx4 v163, s[44:47], s0 offen offset:1024 lds
    s_add_u32 s2, s80, 2048
    buffer_load_dwordx4 v162, s[44:47], s2 offen offset:2048 lds
    s_add_u32 s0, s80, 3072
    buffer_load_dwordx4 v163, s[44:47], s0 offen offset:3072 lds
    s_add_u32 m0, s84, 0
    s_add_u32 s2, s81, 0
    buffer_load_dwordx4 v164, s[48:51], s2 offen offset:0 lds
    s_add_u32 s0, s81, 7168
    buffer_load_dwordx4 v165, s[48:51], s0 offen offset:1024 lds
    s_add_u32 m0, s85, 0
    s_add_u32 s2, s82, 0
    buffer_load_dwordx4 v166, s[52:55], s2 offen offset:0 lds
    s_add_u32 s0, s82, 13312
    buffer_load_dwordx4 v166, s[52:55], s0 offen offset:1024 lds
    s_add_u32 s2, s82, 26624
    buffer_load_dwordx4 v166, s[52:55], s2 offen offset:2048 lds
    s_add_u32 s0, s82, 39936
    buffer_load_dwordx4 v166, s[52:55], s0 offen offset:3072 lds
    s_mov_b32 s56, s40
    s_and_b32 s57, s41, 0xffff
    s_mov_b32 s58, 0x10000000
    s_mov_b32 s59, 0x20000
    s_mov_b32 s76, s30
    s_and_b32 s77, s31, 0xffff
    s_mov_b32 s78, 0xe00
    s_mov_b32 s79, 0x20000
    s_lshl_b32 s86, s7, 6
    s_add_u32 s86, s86, s94
    v_add_u32 v6, s86, v1
    v_lshlrev_b32 v6, 1, v6
    v_cmp_gt_u32 vcc, 32, v1
    v_mov_b32 v11, 0x40000000
    s_nop 0
    v_cndmask_b32 v6, v11, v6, vcc
    buffer_load_ushort v216, v6, s[76:79], 0 offen
    buffer_load_ushort v220, v6, s[76:79], 0 offen offset:64
    v_mov_b32 v11, 0x3f80
    v_cndmask_b32 v224, 0, v11, vcc
    v_mov_b32 v217, 0
    v_mov_b32 v218, 0
    v_mov_b32 v219, 0
    v_mov_b32 v221, 0
    v_mov_b32 v222, 0
    v_mov_b32 v223, 0
    v_mov_b32 v225, 0
    v_mov_b32 v226, 0
    v_mov_b32 v227, 0
    s_add_u32 m0, s83, 16384
    s_add_u32 s2, s80, 128
    buffer_load_dwordx4 v162, s[44:47], s2 offen offset:0 lds
    s_add_u32 s0, s80, 1152
    buffer_load_dwordx4 v163, s[44:47], s0 offen offset:1024 lds
    s_add_u32 s2, s80, 2176
    buffer_load_dwordx4 v162, s[44:47], s2 offen offset:2048 lds
    s_add_u32 s0, s80, 3200
    buffer_load_dwordx4 v163, s[44:47], s0 offen offset:3072 lds
    s_add_u32 m0, s84, 8192
    s_add_u32 s2, s81, 128
    buffer_load_dwordx4 v164, s[48:51], s2 offen offset:0 lds
    s_add_u32 s0, s81, 7296
    buffer_load_dwordx4 v165, s[48:51], s0 offen offset:1024 lds
    s_add_u32 m0, s85, 16384
    s_add_u32 s2, s82, 229376
    buffer_load_dwordx4 v166, s[52:55], s2 offen offset:0 lds
    s_add_u32 s0, s82, 242688
    buffer_load_dwordx4 v166, s[52:55], s0 offen offset:1024 lds
    s_add_u32 s2, s82, 256000
    buffer_load_dwordx4 v166, s[52:55], s2 offen offset:2048 lds
    s_add_u32 s0, s82, 269312
    buffer_load_dwordx4 v166, s[52:55], s0 offen offset:3072 lds
    s_mov_b32 s92, 0x3fb8aa3b
    s_mov_b32 s93, 0x3fb8aa3b
    s_mov_b32 s98, 0x05040100
    s_mov_b32 s99, 0x07060302
    v_and_b32 v2, 31, v1
    v_lshrrev_b32 v3, 5, v1
    v_bfe_u32 v4, v2, 1, 3
    v_xor_b32 v4, v4, v3
    v_lshlrev_b32 v5, 7, v2
    s_lshl_b32 s86, s6, 13
    s_lshl_b32 s87, s7, 12
    s_add_u32 s87, s87, 49152
    v_xor_b32 v6, 0, v4
    v_lshl_add_u32 v6, v6, 4, v5
    v_add_u32 v152, s86, v6
    v_add_u32 v156, s87, v6
    v_xor_b32 v6, 2, v4
    v_lshl_add_u32 v6, v6, 4, v5
    v_add_u32 v153, s86, v6
    v_add_u32 v157, s87, v6
    v_xor_b32 v6, 4, v4
    v_lshl_add_u32 v6, v6, 4, v5
    v_add_u32 v154, s86, v6
    v_add_u32 v158, s87, v6
    v_xor_b32 v6, 6, v4
    v_lshl_add_u32 v6, v6, 4, v5
    v_add_u32 v155, s86, v6
    v_add_u32 v159, s87, v6
    v_lshl_add_u32 v5, v3, 3, v7
    v_lshlrev_b32 v5, 8, v5
    v_bfe_u32 v6, v1, 4, 1
    v_lshl_add_u32 v5, v6, 5, v5
    v_lshl_add_u32 v5, v10, 3, v5
    v_add_u32 v5, 73728, v5
    s_lshl_b32 s86, s7, 1
    s_add_u32 s87, s86, 0
    v_xor_b32 v6, s87, v7
    v_lshl_add_u32 v160, v6, 6, v5
    s_add_u32 s87, s86, 1
    v_xor_b32 v6, s87, v7
    v_lshl_add_u32 v161, v6, 6, v5
    s_waitcnt vmcnt(11)
    v_mfma_f32_32x32x16_bf16 v[48:63], v[216:219], v[224:227], 0
    v_mfma_f32_32x32x16_bf16 v[64:79], v[216:219], v[224:227], 0
    s_waitcnt vmcnt(10)
    v_mfma_f32_32x32x16_bf16 v[80:95], v[220:223], v[224:227], 0
    v_mfma_f32_32x32x16_bf16 v[96:111], v[220:223], v[224:227], 0
    s_barrier
    ds_read_b128 v[112:115], v152 offset:0
    ds_read_b128 v[120:123], v156 offset:0
    ds_read_b128 v[116:119], v152 offset:4096
    ds_read_b64_tr_b16 v[124:125], v160 offset:0
    ds_read_b64_tr_b16 v[126:127], v160 offset:1024
    ds_read_b64_tr_b16 v[128:129], v161 offset:0
    ds_read_b64_tr_b16 v[130:131], v161 offset:1024
    s_add_u32 m0, s83, 32768
    s_add_u32 s2, s80, 256
    buffer_load_dwordx4 v162, s[44:47], s2 offen offset:0 lds
    s_add_u32 s0, s80, 1280
    buffer_load_dwordx4 v163, s[44:47], s0 offen offset:1024 lds
    v_mov_b32 v14, 13631488
    v_mov_b32 v15, 0
    s_cmp_eq_u32 s1, 1
    s_cbranch_scc0 noepoch_1
    buffer_load_dword v15, v14, s[56:59], 0 offen sc1
noepoch_1:
    v_lshrrev_b32 v12, 5, v1
    s_lshl_b32 s86, s5, 1
    v_add_u32 v12, s86, v12
    v_and_b32 v3, 31, v1
    s_lshl_b32 s86, s3, 7
    s_lshl_b32 s87, s4, 3
    s_add_u32 s86, s86, s87
    v_add_u32 v12, s86, v12
    v_lshlrev_b32 v4, 10, v12
    v_lshlrev_b32 v3, 5, v3
    s_waitcnt lgkmcnt(5)
    v_mfma_f32_32x32x16_bf16 v[16:31], v[112:115], v[120:123], 0
    ds_read_b128 v[132:135], v153 offset:0
    ds_read_b128 v[140:143], v157 offset:0
    s_add_u32 s2, s80, 2304
    v_add_u32 v4, v4, v3
    global_load_dwordx4 v[196:199], v4, s[8:9]
    global_load_dwordx4 v[200:203], v4, s[8:9] offset:16
    global_load_dwordx4 v[204:207], v3, s[34:35]
    s_waitcnt lgkmcnt(6)
    v_mfma_f32_32x32x16_bf16 v[32:47], v[116:119], v[120:123], 0
    ds_read_b128 v[136:139], v153 offset:4096
    ds_read_b64_tr_b16 v[144:145], v160 offset:4096
    s_add_u32 s0, s80, 3328
    global_load_dwordx4 v[208:211], v3, s[34:35] offset:16
    s_lshl_b32 s86, s4, 5
    s_lshl_b32 s87, s7, 4
    s_add_u32 s86, s86, s87
    s_waitcnt lgkmcnt(6)
    v_mfma_f32_32x32x16_bf16 v[48:63], v[124:127], v[112:115], v[48:63]
    ds_read_b64_tr_b16 v[146:147], v160 offset:5120
    ds_read_b64_tr_b16 v[148:149], v161 offset:4096
    ds_read_b64_tr_b16 v[150:151], v161 offset:5120
    v_and_b32 v5, 15, v1
    v_add_u32 v5, s86, v5
    v_lshlrev_b32 v5, 1, v5
    v_mfma_f32_32x32x16_bf16 v[64:79], v[124:127], v[116:119], v[64:79]
    buffer_load_dwordx4 v162, s[44:47], s2 offen offset:2048 lds
    s_waitcnt lgkmcnt(7)
    v_mfma_f32_32x32x16_bf16 v[80:95], v[128:131], v[112:115], v[80:95]
    buffer_load_dwordx4 v163, s[44:47], s0 offen offset:3072 lds
    s_add_u32 m0, s84, 16384
    s_add_u32 s2, s81, 256
    v_mfma_f32_32x32x16_bf16 v[96:111], v[128:131], v[116:119], v[96:111]
    buffer_load_dwordx4 v164, s[48:51], s2 offen offset:0 lds
    s_waitcnt lgkmcnt(5)
    v_mfma_f32_32x32x16_bf16 v[16:31], v[132:135], v[140:143], v[16:31]
    ds_read_b128 v[112:115], v154 offset:0
    ds_read_b128 v[120:123], v158 offset:0
    s_add_u32 s0, s81, 7424
    global_load_ushort v212, v5, s[10:11]
    global_load_ushort v213, v5, s[12:13]
    global_load_ushort v214, v5, s[22:23]
    s_waitcnt lgkmcnt(6)
    v_mfma_f32_32x32x16_bf16 v[32:47], v[136:139], v[140:143], v[32:47]
    ds_read_b128 v[116:119], v154 offset:4096
    ds_read_b64_tr_b16 v[124:125], v160 offset:8192
    s_lshl_b32 s88, s3, 4
    s_add_u32 s88, s88, s4
    s_cmp_lt_u32 s88, 150
    s_cselect_b32 s26, s28, s14
    s_cselect_b32 s27, s29, s15
    s_cselect_b32 s86, 0, 150
    s_mov_b32 s87, 511
    s_cselect_b32 s87, 1791, s87
    s_waitcnt lgkmcnt(6)
    v_mfma_f32_32x32x16_bf16 v[48:63], v[144:147], v[132:135], v[48:63]
    ds_read_b64_tr_b16 v[126:127], v160 offset:9216
    ds_read_b64_tr_b16 v[128:129], v161 offset:8192
    s_cmp_lt_u32 s88, 193
    s_cselect_b32 s26, s26, s16
    s_cselect_b32 s27, s27, s17
    s_cselect_b32 s86, s86, 193
    s_sub_u32 s88, s88, s86
    s_mul_i32 s88, s88, 12
    v_mfma_f32_32x32x16_bf16 v[64:79], v[144:147], v[136:139], v[64:79]
    ds_read_b64_tr_b16 v[130:131], v161 offset:9216
    s_add_u32 s88, s88, s5
    v_lshlrev_b32 v8, 4, v1
    s_waitcnt lgkmcnt(7)
    v_mfma_f32_32x32x16_bf16 v[80:95], v[148:151], v[132:135], v[80:95]
    buffer_load_dwordx4 v165, s[48:51], s0 offen offset:1024 lds
    s_add_u32 m0, s85, 32768
    s_add_u32 s2, s82, 458752
    v_mfma_f32_32x32x16_bf16 v[96:111], v[148:151], v[136:139], v[96:111]
    buffer_load_dwordx4 v166, s[52:55], s2 offen offset:0 lds
    s_waitcnt lgkmcnt(5)
    v_mfma_f32_32x32x16_bf16 v[16:31], v[112:115], v[120:123], v[16:31]
    ds_read_b128 v[132:135], v155 offset:0
    ds_read_b128 v[140:143], v159 offset:0
    s_add_u32 s0, s82, 472064
    s_min_u32 s86, s88, s87
    s_lshl_b32 s86, s86, 10
    v_add_u32 v228, s86, v8
    s_add_u32 s88, s88, 4
    s_waitcnt lgkmcnt(6)
    v_mfma_f32_32x32x16_bf16 v[32:47], v[116:119], v[120:123], v[32:47]
    ds_read_b128 v[136:139], v155 offset:4096
    ds_read_b64_tr_b16 v[144:145], v160 offset:12288
    s_add_u32 s2, s82, 485376
    s_min_u32 s86, s88, s87
    s_lshl_b32 s86, s86, 10
    v_add_u32 v229, s86, v8
    s_add_u32 s88, s88, 4
    s_waitcnt lgkmcnt(6)
    v_mfma_f32_32x32x16_bf16 v[48:63], v[124:127], v[112:115], v[48:63]
    ds_read_b64_tr_b16 v[146:147], v160 offset:13312
    ds_read_b64_tr_b16 v[148:149], v161 offset:12288
    ds_read_b64_tr_b16 v[150:151], v161 offset:13312
    s_min_u32 s86, s88, s87
    s_lshl_b32 s86, s86, 10
    v_add_u32 v230, s86, v8
    s_add_u32 s88, s88, 4
    v_mfma_f32_32x32x16_bf16 v[64:79], v[124:127], v[116:119], v[64:79]
    buffer_load_dwordx4 v166, s[52:55], s0 offen offset:1024 lds
    s_add_u32 s0, s82, 498688
    s_waitcnt lgkmcnt(7)
    v_mfma_f32_32x32x16_bf16 v[80:95], v[128:131], v[112:115], v[80:95]
    buffer_load_dwordx4 v166, s[52:55], s2 offen offset:2048 lds
    v_mfma_f32_32x32x16_bf16 v[96:111], v[128:131], v[116:119], v[96:111]
    buffer_load_dwordx4 v166, s[52:55], s0 offen offset:3072 lds
    global_load_dwordx4 v[216:219], v228, s[26:27]
    global_load_dwordx4 v[220:223], v229, s[26:27]
    global_load_dwordx4 v[224:227], v230, s[26:27]
    s_waitcnt vmcnt(20) lgkmcnt(0)
    s_barrier
    v_mfma_f32_32x32x16_bf16 v[16:31], v[132:135], v[140:143], v[16:31]
    ds_read_b128 v[112:115], v152 offset:16384
    ds_read_b128 v[120:123], v156 offset:8192
    s_add_u32 m0, s83, 0
    s_add_u32 s2, s80, 384
    v_mfma_f32_32x32x16_bf16 v[32:47], v[136:139], v[140:143], v[32:47]
    ds_read_b128 v[116:119], v152 offset:20480
    ds_read_b64_tr_b16 v[124:125], v160 offset:16384
    s_add_u32 s0, s80, 1408
    v_mfma_f32_32x32x16_bf16 v[48:63], v[144:147], v[132:135], v[48:63]
    ds_read_b64_tr_b16 v[126:127], v160 offset:17408
    ds_read_b64_tr_b16 v[128:129], v161 offset:16384
    v_mfma_f32_32x32x16_bf16 v[64:79], v[144:147], v[136:139], v[64:79]
    ds_read_b64_tr_b16 v[130:131], v161 offset:17408
    v_mfma_f32_32x32x16_bf16 v[80:95], v[148:151], v[132:135], v[80:95]
    buffer_load_dwordx4 v162, s[44:47], s2 offen offset:0 lds
    v_mfma_f32_32x32x16_bf16 v[96:111], v[148:151], v[136:139], v[96:111]
    buffer_load_dwordx4 v163, s[44:47], s0 offen offset:1024 lds
    s_waitcnt lgkmcnt(5)
    v_mfma_f32_32x32x16_bf16 v[16:31], v[112:115], v[120:123], v[16:31]
    ds_read_b128 v[132:135], v153 offset:16384
    ds_read_b128 v[140:143], v157 offset:8192
    s_add_u32 s2, s80, 2432
    s_waitcnt lgkmcnt(6)
    v_mfma_f32_32x32x16_bf16 v[32:47], v[116:119], v[120:123], v[32:47]
    ds_read_b128 v[136:139], v153 offset:20480
    ds_read_b64_tr_b16 v[144:145], v160 offset:20480
    s_add_u32 s0, s80, 3456
    s_waitcnt lgkmcnt(6)
    v_mfma_f32_32x32x16_bf16 v[48:63], v[124:127], v[112:115], v[48:63]
    ds_read_b64_tr_b16 v[146:147], v160 offset:21504
    ds_read_b64_tr_b16 v[148:149], v161 offset:20480
    ds_read_b64_tr_b16 v[150:151], v161 offset:21504
    v_mfma_f32_32x32x16_bf16 v[64:79], v[124:127], v[116:119], v[64:79]
    buffer_load_dwordx4 v162, s[44:47], s2 offen offset:2048 lds
    s_waitcnt lgkmcnt(7)
    v_mfma_f32_32x32x16_bf16 v[80:95], v[128:131], v[112:115], v[80:95]
    buffer_load_dwordx4 v163, s[44:47], s0 offen offset:3072 lds
    s_add_u32 m0, s84, 0
    s_add_u32 s2, s81, 384
    v_mfma_f32_32x32x16_bf16 v[96:111], v[128:131], v[116:119], v[96:111]
    buffer_load_dwordx4 v164, s[48:51], s2 offen offset:0 lds
    s_waitcnt lgkmcnt(5)
    v_mfma_f32_32x32x16_bf16 v[16:31], v[132:135], v[140:143], v[16:31]
    ds_read_b128 v[112:115], v154 offset:16384
    ds_read_b128 v[120:123], v158 offset:8192
    s_add_u32 s0, s81, 7552
    s_waitcnt lgkmcnt(6)
    v_mfma_f32_32x32x16_bf16 v[32:47], v[136:139], v[140:143], v[32:47]
    ds_read_b128 v[116:119], v154 offset:20480
    ds_read_b64_tr_b16 v[124:125], v160 offset:24576
    s_waitcnt lgkmcnt(6)
    v_mfma_f32_32x32x16_bf16 v[48:63], v[144:147], v[132:135], v[48:63]
    ds_read_b64_tr_b16 v[126:127], v160 offset:25600
    ds_read_b64_tr_b16 v[128:129], v161 offset:24576
    v_mfma_f32_32x32x16_bf16 v[64:79], v[144:147], v[136:139], v[64:79]
    ds_read_b64_tr_b16 v[130:131], v161 offset:25600
    s_waitcnt lgkmcnt(7)
    v_mfma_f32_32x32x16_bf16 v[80:95], v[148:151], v[132:135], v[80:95]
    buffer_load_dwordx4 v165, s[48:51], s0 offen offset:1024 lds
    s_add_u32 m0, s85, 0
    s_add_u32 s2, s82, 688128
    v_mfma_f32_32x32x16_bf16 v[96:111], v[148:151], v[136:139], v[96:111]
    buffer_load_dwordx4 v166, s[52:55], s2 offen offset:0 lds
    s_waitcnt lgkmcnt(5)
    v_mfma_f32_32x32x16_bf16 v[16:31], v[112:115], v[120:123], v[16:31]
    ds_read_b128 v[132:135], v155 offset:16384
    ds_read_b128 v[140:143], v159 offset:8192
    s_add_u32 s0, s82, 701440
    s_waitcnt lgkmcnt(6)
    v_mfma_f32_32x32x16_bf16 v[32:47], v[116:119], v[120:123], v[32:47]
    ds_read_b128 v[136:139], v155 offset:20480
    ds_read_b64_tr_b16 v[144:145], v160 offset:28672
    s_add_u32 s2, s82, 714752
    s_waitcnt lgkmcnt(6)
    v_mfma_f32_32x32x16_bf16 v[48:63], v[124:127], v[112:115], v[48:63]
    ds_read_b64_tr_b16 v[146:147], v160 offset:29696
    ds_read_b64_tr_b16 v[148:149], v161 offset:28672
    ds_read_b64_tr_b16 v[150:151], v161 offset:29696
    v_mfma_f32_32x32x16_bf16 v[64:79], v[124:127], v[116:119], v[64:79]
    buffer_load_dwordx4 v166, s[52:55], s0 offen offset:1024 lds
    s_add_u32 s0, s82, 728064
    s_waitcnt lgkmcnt(7)
    v_mfma_f32_32x32x16_bf16 v[80:95], v[128:131], v[112:115], v[80:95]
    buffer_load_dwordx4 v166, s[52:55], s2 offen offset:2048 lds
    v_mfma_f32_32x32x16_bf16 v[96:111], v[128:131], v[116:119], v[96:111]
    buffer_load_dwordx4 v166, s[52:55], s0 offen offset:3072 lds
    s_waitcnt vmcnt(13) lgkmcnt(0)
    s_barrier
    s_cmp_eq_u32 s1, 1
    s_cbranch_scc0 noepoch_2
    v_add_u32 v15, 2, v15
    v_or_b32 v15, 1, v15
    v_mov_b32 v13, 0
    s_mov_b64 s[42:43], exec
    s_mov_b64 exec, 1
    buffer_store_dword v15, v14, s[56:59], 0 offen sc1
    global_store_dword v13, v15, s[38:39] sc1
    s_mov_b64 exec, s[42:43]
noepoch_2:
    v_mfma_f32_32x32x16_bf16 v[16:31], v[132:135], v[140:143], v[16:31]
    ds_read_b128 v[112:115], v152 offset:32768
    ds_read_b128 v[120:123], v156 offset:16384
    s_add_u32 m0, s83, 16384
    s_add_u32 s2, s80, 512
    v_mov_b32 v7, 0
    v_dot2_f32_bf16 v7, v196, v204, v7
    s_nop 1
    v_mfma_f32_32x32x16_bf16 v[32:47], v[136:139], v[140:143], v[32:47]
    ds_read_b128 v[116:119], v152 offset:36864
    ds_read_b64_tr_b16 v[124:125], v160 offset:32768
    s_add_u32 s0, s80, 1536
    v_dot2_f32_bf16 v7, v197, v205, v7
    s_nop 1
    v_mfma_f32_32x32x16_bf16 v[48:63], v[144:147], v[132:135], v[48:63]
    ds_read_b64_tr_b16 v[126:127], v160 offset:33792
    ds_read_b64_tr_b16 v[128:129], v161 offset:32768
    v_dot2_f32_bf16 v7, v198, v206, v7
    s_nop 1
    v_mfma_f32_32x32x16_bf16 v[64:79], v[144:147], v[136:139], v[64:79]
    ds_read_b64_tr_b16 v[130:131], v161 offset:33792
    v_dot2_f32_bf16 v7, v199, v207, v7
    s_nop 1
    v_mfma_f32_32x32x16_bf16 v[80:95], v[148:151], v[132:135], v[80:95]
    buffer_load_dwordx4 v162, s[44:47], s2 offen offset:0 lds
    v_mfma_f32_32x32x16_bf16 v[96:111], v[148:151], v[136:139], v[96:111]
    buffer_load_dwordx4 v163, s[44:47], s0 offen offset:1024 lds
    s_waitcnt lgkmcnt(5)
    v_mfma_f32_32x32x16_bf16 v[16:31], v[112:115], v[120:123], v[16:31]
    ds_read_b128 v[132:135], v153 offset:32768
    ds_read_b128 v[140:143], v157 offset:16384
    s_add_u32 s2, s80, 2560
    v_dot2_f32_bf16 v7, v200, v208, v7
    v_dot2_f32_bf16 v7, v201, v209, v7
    s_waitcnt lgkmcnt(6)
    s_nop 0
    v_mfma_f32_32x32x16_bf16 v[32:47], v[116:119], v[120:123], v[32:47]
    ds_read_b128 v[136:139], v153 offset:36864
    ds_read_b64_tr_b16 v[144:145], v160 offset:36864
    s_add_u32 s0, s80, 3584
    v_dot2_f32_bf16 v7, v202, v210, v7
    v_dot2_f32_bf16 v7, v203, v211, v7
    s_waitcnt lgkmcnt(6)
    s_nop 0
    v_mfma_f32_32x32x16_bf16 v[48:63], v[124:127], v[112:115], v[48:63]
    ds_read_b64_tr_b16 v[146:147], v160 offset:37888
    ds_read_b64_tr_b16 v[148:149], v161 offset:36864
    ds_read_b64_tr_b16 v[150:151], v161 offset:37888
    v_add_f32_dpp v7, v7, v7 row_ror:8 row_mask:0xf bank_mask:0xf
    s_nop 1
    v_add_f32_dpp v7, v7, v7 row_ror:4 row_mask:0xf bank_mask:0xf
    v_mfma_f32_32x32x16_bf16 v[64:79], v[124:127], v[116:119], v[64:79]
    buffer_load_dwordx4 v162, s[44:47], s2 offen offset:2048 lds
    s_waitcnt lgkmcnt(7)
    v_mfma_f32_32x32x16_bf16 v[80:95], v[128:131], v[112:115], v[80:95]
    buffer_load_dwordx4 v163, s[44:47], s0 offen offset:3072 lds
    s_add_u32 m0, s84, 8192
    s_add_u32 s2, s81, 512
    v_mfma_f32_32x32x16_bf16 v[96:111], v[128:131], v[116:119], v[96:111]
    buffer_load_dwordx4 v164, s[48:51], s2 offen offset:0 lds
    s_waitcnt lgkmcnt(5)
    v_mfma_f32_32x32x16_bf16 v[16:31], v[132:135], v[140:143], v[16:31]
    ds_read_b128 v[112:115], v154 offset:32768
    ds_read_b128 v[120:123], v158 offset:16384
    s_add_u32 s0, s81, 7680
    v_add_f32_dpp v7, v7, v7 row_ror:2 row_mask:0xf bank_mask:0xf
    s_nop 1
    v_add_f32_dpp v7, v7, v7 row_ror:1 row_mask:0xf bank_mask:0xf
    s_waitcnt lgkmcnt(6)
    v_mfma_f32_32x32x16_bf16 v[32:47], v[136:139], v[140:143], v[32:47]
    ds_read_b128 v[116:119], v154 offset:36864
    ds_read_b64_tr_b16 v[124:125], v160 offset:40960
    v_mov_b32 v8, v7
    s_waitcnt lgkmcnt(6)
    v_mfma_f32_32x32x16_bf16 v[48:63], v[144:147], v[132:135], v[48:63]
    ds_read_b64_tr_b16 v[126:127], v160 offset:41984
    ds_read_b64_tr_b16 v[128:129], v161 offset:40960
    v_add_f32_dpp v8, v7, v8 row_bcast:15 row_mask:0xa bank_mask:0xf
    v_mfma_f32_32x32x16_bf16 v[64:79], v[144:147], v[136:139], v[64:79]
    ds_read_b64_tr_b16 v[130:131], v161 offset:41984
    v_mul_f32 v8, 0xbfb8aa3b, v8
    s_waitcnt lgkmcnt(7)
    v_mfma_f32_32x32x16_bf16 v[80:95], v[148:151], v[132:135], v[80:95]
    buffer_load_dwordx4 v165, s[48:51], s0 offen offset:1024 lds
    s_add_u32 m0, s85, 16384
    s_add_u32 s2, s82, 917504
    v_mfma_f32_32x32x16_bf16 v[96:111], v[148:151], v[136:139], v[96:111]
    buffer_load_dwordx4 v166, s[52:55], s2 offen offset:0 lds
    s_waitcnt lgkmcnt(5)
    v_mfma_f32_32x32x16_bf16 v[16:31], v[112:115], v[120:123], v[16:31]
    ds_read_b128 v[132:135], v155 offset:32768
    ds_read_b128 v[140:143], v159 offset:16384
    s_add_u32 s0, s82, 930816
    v_exp_f32 v8, v8
    s_nop 0
    v_add_f32 v8, 1.0, v8
    s_waitcnt lgkmcnt(6)
    v_mfma_f32_32x32x16_bf16 v[32:47], v[116:119], v[120:123], v[32:47]
    ds_read_b128 v[136:139], v155 offset:36864
    ds_read_b64_tr_b16 v[144:145], v160 offset:45056
    s_add_u32 s2, s82, 944128
    v_rcp_f32 v8, v8
    v_lshlrev_b32 v9, 2, v12
    s_waitcnt lgkmcnt(6)
    v_mfma_f32_32x32x16_bf16 v[48:63], v[124:127], v[112:115], v[48:63]
    ds_read_b64_tr_b16 v[146:147], v160 offset:46080
    ds_read_b64_tr_b16 v[148:149], v161 offset:45056
    ds_read_b64_tr_b16 v[150:151], v161 offset:46080
    v_add_u32 v9, 12582912, v9
    s_mov_b64 s[42:43], exec
    s_mov_b32 exec_lo, 0x10000
    s_mov_b32 exec_hi, 0x10000
    buffer_store_dword v8, v9, s[56:59], 0 offen sc1
    s_mov_b64 exec, s[42:43]
    v_mfma_f32_32x32x16_bf16 v[64:79], v[124:127], v[116:119], v[64:79]
    buffer_load_dwordx4 v166, s[52:55], s0 offen offset:1024 lds
    s_add_u32 s0, s82, 957440
    s_waitcnt lgkmcnt(7)
    v_mfma_f32_32x32x16_bf16 v[80:95], v[128:131], v[112:115], v[80:95]
    buffer_load_dwordx4 v166, s[52:55], s2 offen offset:2048 lds
    v_mfma_f32_32x32x16_bf16 v[96:111], v[128:131], v[116:119], v[96:111]
    buffer_load_dwordx4 v166, s[52:55], s0 offen offset:3072 lds
    s_waitcnt vmcnt(11) lgkmcnt(0)
    s_barrier
    v_mfma_f32_32x32x16_bf16 v[16:31], v[132:135], v[140:143], v[16:31]
    ds_read_b128 v[112:115], v152 offset:0
    ds_read_b128 v[120:123], v156 offset:0
    s_add_u32 m0, s83, 32768
    s_add_u32 s2, s80, 640
    s_lshl_b32 s88, s3, 4
    s_add_u32 s88, s88, s4
    s_cmp_lt_u32 s88, 150
    s_cselect_b32 s26, s32, s18
    s_cselect_b32 s27, s33, s19
    s_cselect_b32 s86, 0, 150
    s_mov_b32 s87, 511
    s_cselect_b32 s87, 1791, s87
    v_mfma_f32_32x32x16_bf16 v[32:47], v[136:139], v[140:143], v[32:47]
    ds_read_b128 v[116:119], v152 offset:4096
    ds_read_b64_tr_b16 v[124:125], v160 offset:0
    s_add_u32 s0, s80, 1664
    s_cmp_lt_u32 s88, 193
    s_cselect_b32 s26, s26, s20
    s_cselect_b32 s27, s27, s21
    s_cselect_b32 s86, s86, 193
    s_sub_u32 s88, s88, s86
    v_mfma_f32_32x32x16_bf16 v[48:63], v[144:147], v[132:135], v[48:63]
    ds_read_b64_tr_b16 v[126:127], v160 offset:1024
    ds_read_b64_tr_b16 v[128:129], v161 offset:0
    s_mul_i32 s88, s88, 12
    s_add_u32 s88, s88, s5
    v_mfma_f32_32x32x16_bf16 v[64:79], v[144:147], v[136:139], v[64:79]
    ds_read_b64_tr_b16 v[130:131], v161 offset:1024
    v_lshlrev_b32 v8, 4, v1
    s_min_u32 s86, s88, s87
    v_mfma_f32_32x32x16_bf16 v[80:95], v[148:151], v[132:135], v[80:95]
    buffer_load_dwordx4 v162, s[44:47], s2 offen offset:0 lds
    v_mfma_f32_32x32x16_bf16 v[96:111], v[148:151], v[136:139], v[96:111]
    buffer_load_dwordx4 v163, s[44:47], s0 offen offset:1024 lds
    s_waitcnt lgkmcnt(5)
    v_mfma_f32_32x32x16_bf16 v[16:31], v[112:115], v[120:123], v[16:31]
    ds_read_b128 v[132:135], v153 offset:0
    ds_read_b128 v[140:143], v157 offset:0
    s_add_u32 s2, s80, 2688
    s_lshl_b32 s86, s86, 10
    v_add_u32 v244, s86, v8
    s_add_u32 s88, s88, 4
    s_min_u32 s86, s88, s87
    s_waitcnt lgkmcnt(6)
    v_mfma_f32_32x32x16_bf16 v[32:47], v[116:119], v[120:123], v[32:47]
    ds_read_b128 v[136:139], v153 offset:4096
    ds_read_b64_tr_b16 v[144:145], v160 offset:4096
    s_add_u32 s0, s80, 3712
    s_lshl_b32 s86, s86, 10
    v_add_u32 v245, s86, v8
    s_add_u32 s88, s88, 4
    s_waitcnt lgkmcnt(6)
    v_mfma_f32_32x32x16_bf16 v[48:63], v[124:127], v[112:115], v[48:63]
    ds_read_b64_tr_b16 v[146:147], v160 offset:5120
    ds_read_b64_tr_b16 v[148:149], v161 offset:4096
    ds_read_b64_tr_b16 v[150:151], v161 offset:5120
    s_min_u32 s86, s88, s87
    s_lshl_b32 s86, s86, 10
    v_add_u32 v246, s86, v8
    v_mfma_f32_32x32x16_bf16 v[64:79], v[124:127], v[116:119], v[64:79]
    buffer_load_dwordx4 v162, s[44:47], s2 offen offset:2048 lds
    s_waitcnt lgkmcnt(7)
    v_mfma_f32_32x32x16_bf16 v[80:95], v[128:131], v[112:115], v[80:95]
    buffer_load_dwordx4 v163, s[44:47], s0 offen offset:3072 lds
    s_add_u32 m0, s84, 16384
    s_add_u32 s2, s81, 640
    v_mfma_f32_32x32x16_bf16 v[96:111], v[128:131], v[116:119], v[96:111]
    buffer_load_dwordx4 v164, s[48:51], s2 offen offset:0 lds
    s_waitcnt lgkmcnt(5)
    v_mfma_f32_32x32x16_bf16 v[16:31], v[132:135], v[140:143], v[16:31]
    ds_read_b128 v[112:115], v154 offset:0
    ds_read_b128 v[120:123], v158 offset:0
    s_add_u32 s0, s81, 7808
    s_add_u32 s88, s88, 4
    v_lshlrev_b32 v212, 16, v212
    v_lshlrev_b32 v213, 16, v213
    s_waitcnt lgkmcnt(6)
    v_mfma_f32_32x32x16_bf16 v[32:47], v[136:139], v[140:143], v[32:47]
    ds_read_b128 v[116:119], v154 offset:4096
    ds_read_b64_tr_b16 v[124:125], v160 offset:8192
    v_lshlrev_b32 v214, 16, v214
    v_mul_f32 v214, s92, v214
    s_waitcnt lgkmcnt(6)
    v_mfma_f32_32x32x16_bf16 v[48:63], v[144:147], v[132:135], v[48:63]
    ds_read_b64_tr_b16 v[126:127], v160 offset:9216
    ds_read_b64_tr_b16 v[128:129], v161 offset:8192
    v_exp_f32 v214, v214
    s_nop 0
    v_cvt_pk_bf16_f32 v214, v214, v214
    v_lshlrev_b32 v214, 16, v214
    v_mfma_f32_32x32x16_bf16 v[64:79], v[144:147], v[136:139], v[64:79]
    ds_read_b64_tr_b16 v[130:131], v161 offset:9216
    v_mul_f32 v2, v214, v212
    v_mul_f32 v2, s92, v2
    s_waitcnt lgkmcnt(7)
    v_mfma_f32_32x32x16_bf16 v[80:95], v[148:151], v[132:135], v[80:95]
    buffer_load_dwordx4 v165, s[48:51], s0 offen offset:1024 lds
    s_add_u32 m0, s85, 32768
    s_add_u32 s2, s82, 1146880
    v_mfma_f32_32x32x16_bf16 v[96:111], v[148:151], v[136:139], v[96:111]
    buffer_load_dwordx4 v166, s[52:55], s2 offen offset:0 lds
    s_waitcnt lgkmcnt(5)
    v_mfma_f32_32x32x16_bf16 v[16:31], v[112:115], v[120:123], v[16:31]
    ds_read_b128 v[132:135], v155 offset:0
    ds_read_b128 v[140:143], v159 offset:0
    s_add_u32 s0, s82, 1160192
    v_mul_f32 v3, v214, v213
    v_mul_f32 v3, 0.15915494, v3
    v_lshrrev_b32 v10, 4, v1
    v_lshlrev_b32 v10, 7, v10
    s_waitcnt lgkmcnt(6)
    v_mfma_f32_32x32x16_bf16 v[32:47], v[116:119], v[120:123], v[32:47]
    ds_read_b128 v[136:139], v155 offset:4096
    ds_read_b64_tr_b16 v[144:145], v160 offset:12288
    s_add_u32 s2, s82, 1173504
    v_cvt_f32_u32 v10, v10
    v_lshrrev_b32 v9, 4, v1
    s_lshl_b32 s86, s6, 2
    v_add_u32 v9, s86, v9
    s_waitcnt lgkmcnt(6)
    v_mfma_f32_32x32x16_bf16 v[48:63], v[124:127], v[112:115], v[48:63]
    ds_read_b64_tr_b16 v[146:147], v160 offset:13312
    ds_read_b64_tr_b16 v[148:149], v161 offset:12288
    ds_read_b64_tr_b16 v[150:151], v161 offset:13312
    v_lshlrev_b32 v9, 4, v9
    v_cvt_f32_u32 v9, v9
    v_mul_f32 v4, 1.0, v2
    v_mfma_f32_32x32x16_bf16 v[64:79], v[124:127], v[116:119], v[64:79]
    buffer_load_dwordx4 v166, s[52:55], s0 offen offset:1024 lds
    s_add_u32 s0, s82, 1186816
    s_waitcnt lgkmcnt(7)
    v_mfma_f32_32x32x16_bf16 v[80:95], v[128:131], v[112:115], v[80:95]
    buffer_load_dwordx4 v166, s[52:55], s2 offen offset:2048 lds
    v_mfma_f32_32x32x16_bf16 v[96:111], v[128:131], v[116:119], v[96:111]
    buffer_load_dwordx4 v166, s[52:55], s0 offen offset:3072 lds
    global_load_dwordx4 v[232:235], v244, s[26:27]
    global_load_dwordx4 v[236:239], v245, s[26:27]
    global_load_dwordx4 v[240:243], v246, s[26:27]
    s_waitcnt vmcnt(13) lgkmcnt(0)
    s_barrier
    v_mfma_f32_32x32x16_bf16 v[16:31], v[132:135], v[140:143], v[16:31]
    ds_read_b128 v[112:115], v152 offset:16384
    ds_read_b128 v[120:123], v156 offset:8192
    s_add_u32 m0, s83, 0
    s_add_u32 s2, s80, 768
    v_mul_f32 v5, 1.0, v3
    v_mfma_f32_32x32x16_bf16 v[32:47], v[136:139], v[140:143], v[32:47]
    ds_read_b128 v[116:119], v152 offset:20480
    ds_read_b64_tr_b16 v[124:125], v160 offset:16384
    s_add_u32 s0, s80, 1792
    v_exp_f32 v4, v4
    v_mfma_f32_32x32x16_bf16 v[48:63], v[144:147], v[132:135], v[48:63]
    ds_read_b64_tr_b16 v[126:127], v160 offset:17408
    ds_read_b64_tr_b16 v[128:129], v161 offset:16384
    v_fract_f32 v5, v5
    v_mfma_f32_32x32x16_bf16 v[64:79], v[144:147], v[136:139], v[64:79]
    ds_read_b64_tr_b16 v[130:131], v161 offset:17408
    v_cos_f32 v6, v5
    v_mfma_f32_32x32x16_bf16 v[80:95], v[148:151], v[132:135], v[80:95]
    buffer_load_dwordx4 v162, s[44:47], s2 offen offset:0 lds
    v_mfma_f32_32x32x16_bf16 v[96:111], v[148:151], v[136:139], v[96:111]
    buffer_load_dwordx4 v163, s[44:47], s0 offen offset:1024 lds
    s_waitcnt lgkmcnt(5)
    v_mfma_f32_32x32x16_bf16 v[16:31], v[112:115], v[120:123], v[16:31]
    ds_read_b128 v[132:135], v153 offset:16384
    ds_read_b128 v[140:143], v157 offset:8192
    s_add_u32 s2, s80, 2816
    v_sin_f32 v11, v5
    v_mul_f32 v168, v4, v6
    s_waitcnt lgkmcnt(6)
    v_mfma_f32_32x32x16_bf16 v[32:47], v[116:119], v[120:123], v[32:47]
    ds_read_b128 v[136:139], v153 offset:20480
    ds_read_b64_tr_b16 v[144:145], v160 offset:20480
    s_add_u32 s0, s80, 3840
    v_mul_f32 v169, v4, v11
    v_mul_f32 v4, 0x41000000, v2
    s_waitcnt lgkmcnt(6)
    v_mfma_f32_32x32x16_bf16 v[48:63], v[124:127], v[112:115], v[48:63]
    ds_read_b64_tr_b16 v[146:147], v160 offset:21504
    ds_read_b64_tr_b16 v[148:149], v161 offset:20480
    ds_read_b64_tr_b16 v[150:151], v161 offset:21504
    v_mul_f32 v5, 0x41000000, v3
    v_mfma_f32_32x32x16_bf16 v[64:79], v[124:127], v[116:119], v[64:79]
    buffer_load_dwordx4 v162, s[44:47], s2 offen offset:2048 lds
    s_waitcnt lgkmcnt(7)
    v_mfma_f32_32x32x16_bf16 v[80:95], v[128:131], v[112:115], v[80:95]
    buffer_load_dwordx4 v163, s[44:47], s0 offen offset:3072 lds
    s_add_u32 m0, s84, 0
    s_add_u32 s2, s81, 768
    v_mfma_f32_32x32x16_bf16 v[96:111], v[128:131], v[116:119], v[96:111]
    buffer_load_dwordx4 v164, s[48:51], s2 offen offset:0 lds
    s_waitcnt lgkmcnt(5)
    v_mfma_f32_32x32x16_bf16 v[16:31], v[132:135], v[140:143], v[16:31]
    ds_read_b128 v[112:115], v154 offset:16384
    ds_read_b128 v[120:123], v158 offset:8192
    s_add_u32 s0, s81, 7936
    v_exp_f32 v4, v4
    v_fract_f32 v5, v5
    s_waitcnt lgkmcnt(6)
    v_mfma_f32_32x32x16_bf16 v[32:47], v[136:139], v[140:143], v[32:47]
    ds_read_b128 v[116:119], v154 offset:20480
    ds_read_b64_tr_b16 v[124:125], v160 offset:24576
    v_cos_f32 v6, v5
    s_waitcnt lgkmcnt(6)
    v_mfma_f32_32x32x16_bf16 v[48:63], v[144:147], v[132:135], v[48:63]
    ds_read_b64_tr_b16 v[126:127], v160 offset:25600
    ds_read_b64_tr_b16 v[128:129], v161 offset:24576
    v_sin_f32 v11, v5
    v_mfma_f32_32x32x16_bf16 v[64:79], v[144:147], v[136:139], v[64:79]
    ds_read_b64_tr_b16 v[130:131], v161 offset:25600
    v_mul_f32 v170, v4, v6
    s_waitcnt lgkmcnt(7)
    v_mfma_f32_32x32x16_bf16 v[80:95], v[148:151], v[132:135], v[80:95]
    buffer_load_dwordx4 v165, s[48:51], s0 offen offset:1024 lds
    s_add_u32 m0, s85, 0
    s_add_u32 s2, s82, 1376256
    v_mfma_f32_32x32x16_bf16 v[96:111], v[148:151], v[136:139], v[96:111]
    buffer_load_dwordx4 v166, s[52:55], s2 offen offset:0 lds
    s_waitcnt lgkmcnt(5)
    v_mfma_f32_32x32x16_bf16 v[16:31], v[112:115], v[120:123], v[16:31]
    ds_read_b128 v[132:135], v155 offset:16384
    ds_read_b128 v[140:143], v159 offset:8192
    s_add_u32 s0, s82, 1389568
    v_mul_f32 v171, v4, v11
    v_mul_f32 v4, 0x41800000, v2
    s_waitcnt lgkmcnt(6)
    v_mfma_f32_32x32x16_bf16 v[32:47], v[116:119], v[120:123], v[32:47]
    ds_read_b128 v[136:139], v155 offset:20480
    ds_read_b64_tr_b16 v[144:145], v160 offset:28672
    s_add_u32 s2, s82, 1402880
    v_mul_f32 v5, 0x41800000, v3
    v_exp_f32 v4, v4
    s_waitcnt lgkmcnt(6)
    v_mfma_f32_32x32x16_bf16 v[48:63], v[124:127], v[112:115], v[48:63]
    ds_read_b64_tr_b16 v[146:147], v160 offset:29696
    ds_read_b64_tr_b16 v[148:149], v161 offset:28672
    ds_read_b64_tr_b16 v[150:151], v161 offset:29696
    v_fract_f32 v5, v5
    v_mfma_f32_32x32x16_bf16 v[64:79], v[124:127], v[116:119], v[64:79]
    buffer_load_dwordx4 v166, s[52:55], s0 offen offset:1024 lds
    s_add_u32 s0, s82, 1416192
    s_waitcnt lgkmcnt(7)
    v_mfma_f32_32x32x16_bf16 v[80:95], v[128:131], v[112:115], v[80:95]
    buffer_load_dwordx4 v166, s[52:55], s2 offen offset:2048 lds
    v_mfma_f32_32x32x16_bf16 v[96:111], v[128:131], v[116:119], v[96:111]
    buffer_load_dwordx4 v166, s[52:55], s0 offen offset:3072 lds
    s_waitcnt vmcnt(13) lgkmcnt(0)
    s_barrier
    v_mfma_f32_32x32x16_bf16 v[16:31], v[132:135], v[140:143], v[16:31]
    ds_read_b128 v[112:115], v152 offset:32768
    ds_read_b128 v[120:123], v156 offset:16384
    s_add_u32 m0, s83, 16384
    s_add_u32 s2, s80, 896
    v_cos_f32 v6, v5
    v_mfma_f32_32x32x16_bf16 v[32:47], v[136:139], v[140:143], v[32:47]
    ds_read_b128 v[116:119], v152 offset:36864
    ds_read_b64_tr_b16 v[124:125], v160 offset:32768
    s_add_u32 s0, s80, 1920
    v_sin_f32 v11, v5
    v_mfma_f32_32x32x16_bf16 v[48:63], v[144:147], v[132:135], v[48:63]
    ds_read_b64_tr_b16 v[126:127], v160 offset:33792
    ds_read_b64_tr_b16 v[128:129], v161 offset:32768
    v_mul_f32 v172, v4, v6
    v_mfma_f32_32x32x16_bf16 v[64:79], v[144:147], v[136:139], v[64:79]
    ds_read_b64_tr_b16 v[130:131], v161 offset:33792
    v_mfma_f32_32x32x16_bf16 v[80:95], v[148:151], v[132:135], v[80:95]
    buffer_load_dwordx4 v162, s[44:47], s2 offen offset:0 lds
    v_mfma_f32_32x32x16_bf16 v[96:111], v[148:151], v[136:139], v[96:111]
    buffer_load_dwordx4 v163, s[44:47], s0 offen offset:1024 lds
    s_waitcnt lgkmcnt(5)
    v_mfma_f32_32x32x16_bf16 v[16:31], v[112:115], v[120:123], v[16:31]
    ds_read_b128 v[132:135], v153 offset:32768
    ds_read_b128 v[140:143], v157 offset:16384
    s_add_u32 s2, s80, 2944
    v_mul_f32 v173, v4, v11
    s_waitcnt lgkmcnt(6)
    v_mfma_f32_32x32x16_bf16 v[32:47], v[116:119], v[120:123], v[32:47]
    ds_read_b128 v[136:139], v153 offset:36864
    ds_read_b64_tr_b16 v[144:145], v160 offset:36864
    s_add_u32 s0, s80, 3968
    v_mul_f32 v4, 0x44000000, v2
    s_waitcnt lgkmcnt(6)
    v_mfma_f32_32x32x16_bf16 v[48:63], v[124:127], v[112:115], v[48:63]
    ds_read_b64_tr_b16 v[146:147], v160 offset:37888
    ds_read_b64_tr_b16 v[148:149], v161 offset:36864
    ds_read_b64_tr_b16 v[150:151], v161 offset:37888
    v_mul_f32 v5, 0x44000000, v3
    v_mfma_f32_32x32x16_bf16 v[64:79], v[124:127], v[116:119], v[64:79]
    buffer_load_dwordx4 v162, s[44:47], s2 offen offset:2048 lds
    s_waitcnt lgkmcnt(7)
    v_mfma_f32_32x32x16_bf16 v[80:95], v[128:131], v[112:115], v[80:95]
    buffer_load_dwordx4 v163, s[44:47], s0 offen offset:3072 lds
    s_add_u32 m0, s84, 8192
    s_add_u32 s2, s81, 896
    v_mfma_f32_32x32x16_bf16 v[96:111], v[128:131], v[116:119], v[96:111]
    buffer_load_dwordx4 v164, s[48:51], s2 offen offset:0 lds
    s_waitcnt lgkmcnt(5)
    v_mfma_f32_32x32x16_bf16 v[16:31], v[132:135], v[140:143], v[16:31]
    ds_read_b128 v[112:115], v154 offset:32768
    ds_read_b128 v[120:123], v158 offset:16384
    s_add_u32 s0, s81, 8064
    v_exp_f32 v4, v4
    s_waitcnt lgkmcnt(6)
    v_mfma_f32_32x32x16_bf16 v[32:47], v[136:139], v[140:143], v[32:47]
    ds_read_b128 v[116:119], v154 offset:36864
    ds_read_b64_tr_b16 v[124:125], v160 offset:40960
    v_fract_f32 v5, v5
    s_waitcnt lgkmcnt(6)
    v_mfma_f32_32x32x16_bf16 v[48:63], v[144:147], v[132:135], v[48:63]
    ds_read_b64_tr_b16 v[126:127], v160 offset:41984
    ds_read_b64_tr_b16 v[128:129], v161 offset:40960
    v_cos_f32 v6, v5
    v_mfma_f32_32x32x16_bf16 v[64:79], v[144:147], v[136:139], v[64:79]
    ds_read_b64_tr_b16 v[130:131], v161 offset:41984
    s_waitcnt lgkmcnt(7)
    v_mfma_f32_32x32x16_bf16 v[80:95], v[148:151], v[132:135], v[80:95]
    buffer_load_dwordx4 v165, s[48:51], s0 offen offset:1024 lds
    s_add_u32 m0, s85, 16384
    s_add_u32 s2, s82, 1605632
    v_mfma_f32_32x32x16_bf16 v[96:111], v[148:151], v[136:139], v[96:111]
    buffer_load_dwordx4 v166, s[52:55], s2 offen offset:0 lds
    s_waitcnt lgkmcnt(5)
    v_mfma_f32_32x32x16_bf16 v[16:31], v[112:115], v[120:123], v[16:31]
    ds_read_b128 v[132:135], v155 offset:32768
    ds_read_b128 v[140:143], v159 offset:16384
    s_add_u32 s0, s82, 1618944
    v_sin_f32 v11, v5
    s_waitcnt lgkmcnt(6)
    v_mfma_f32_32x32x16_bf16 v[32:47], v[116:119], v[120:123], v[32:47]
    ds_read_b128 v[136:139], v155 offset:36864
    ds_read_b64_tr_b16 v[144:145], v160 offset:45056
    s_add_u32 s2, s82, 1632256
    v_mul_f32 v174, v4, v6
    s_waitcnt lgkmcnt(6)
    v_mfma_f32_32x32x16_bf16 v[48:63], v[124:127], v[112:115], v[48:63]
    ds_read_b64_tr_b16 v[146:147], v160 offset:46080
    ds_read_b64_tr_b16 v[148:149], v161 offset:45056
    ds_read_b64_tr_b16 v[150:151], v161 offset:46080
    v_mul_f32 v175, v4, v11
    v_mfma_f32_32x32x16_bf16 v[64:79], v[124:127], v[116:119], v[64:79]
    buffer_load_dwordx4 v166, s[52:55], s0 offen offset:1024 lds
    s_add_u32 s0, s82, 1645568
    s_waitcnt lgkmcnt(7)
    v_mfma_f32_32x32x16_bf16 v[80:95], v[128:131], v[112:115], v[80:95]
    buffer_load_dwordx4 v166, s[52:55], s2 offen offset:2048 lds
    v_mfma_f32_32x32x16_bf16 v[96:111], v[128:131], v[116:119], v[96:111]
    buffer_load_dwordx4 v166, s[52:55], s0 offen offset:3072 lds
    v_mov_b32 v13, 0
    global_load_dword v14, v13, s[38:39] sc1
    s_waitcnt vmcnt(11) lgkmcnt(0)
    s_barrier
    v_mfma_f32_32x32x16_bf16 v[16:31], v[132:135], v[140:143], v[16:31]
    ds_read_b128 v[112:115], v152 offset:0
    ds_read_b128 v[120:123], v156 offset:0
    v_mul_f32 v4, v10, v2
    v_mul_f32 v5, v10, v3
    v_exp_f32 v4, v4
    v_mfma_f32_32x32x16_bf16 v[32:47], v[136:139], v[140:143], v[32:47]
    ds_read_b128 v[116:119], v152 offset:4096
    ds_read_b64_tr_b16 v[124:125], v160 offset:0
    v_fract_f32 v5, v5
    v_cos_f32 v6, v5
    v_mfma_f32_32x32x16_bf16 v[48:63], v[144:147], v[132:135], v[48:63]
    ds_read_b64_tr_b16 v[126:127], v160 offset:1024
    ds_read_b64_tr_b16 v[128:129], v161 offset:0
    v_sin_f32 v11, v5
    v_mul_f32 v250, v4, v6
    v_mul_f32 v251, v4, v11
    v_mfma_f32_32x32x16_bf16 v[64:79], v[144:147], v[136:139], v[64:79]
    ds_read_b64_tr_b16 v[130:131], v161 offset:1024
    v_mul_f32 v4, v9, v2
    v_mul_f32 v5, v9, v3
    v_mfma_f32_32x32x16_bf16 v[80:95], v[148:151], v[132:135], v[80:95]
    v_exp_f32 v4, v4
    v_fract_f32 v5, v5
    v_cos_f32 v6, v5
    v_mfma_f32_32x32x16_bf16 v[96:111], v[148:151], v[136:139], v[96:111]
    v_sin_f32 v11, v5
    v_mul_f32 v230, v4, v6
    s_waitcnt lgkmcnt(5)
    v_mfma_f32_32x32x16_bf16 v[16:31], v[112:115], v[120:123], v[16:31]
    ds_read_b128 v[132:135], v153 offset:0
    ds_read_b128 v[140:143], v157 offset:0
    v_mul_f32 v231, v4, v11
    v_add_f32 v4, -1.0, v168
    v_mul_f32 v5, v212, v212
    s_waitcnt lgkmcnt(6)
    v_mfma_f32_32x32x16_bf16 v[32:47], v[116:119], v[120:123], v[32:47]
    ds_read_b128 v[136:139], v153 offset:4096
    ds_read_b64_tr_b16 v[144:145], v160 offset:4096
    v_fmac_f32 v5, v213, v213
    v_rcp_f32 v5, v5
    v_mul_f32 v6, v4, v212
    s_waitcnt lgkmcnt(6)
    v_mfma_f32_32x32x16_bf16 v[48:63], v[124:127], v[112:115], v[48:63]
    ds_read_b64_tr_b16 v[146:147], v160 offset:5120
    ds_read_b64_tr_b16 v[148:149], v161 offset:4096
    v_add_f32 v5, v5, v5
    v_fmac_f32 v6, v169, v213
    v_mfma_f32_32x32x16_bf16 v[64:79], v[124:127], v[116:119], v[64:79]
    ds_read_b64_tr_b16 v[150:151], v161 offset:5120
    v_mul_f32 v11, v169, v212
    v_fma_f32 v11, -v4, v213, v11
    v_mul_f32 v176, v6, v5
    s_waitcnt lgkmcnt(7)
    v_mfma_f32_32x32x16_bf16 v[80:95], v[128:131], v[112:115], v[80:95]
    v_mul_f32 v177, v11, v5
    s_mov_b32 s60, s32
    s_and_b32 s61, s33, 0xffff
    v_mfma_f32_32x32x16_bf16 v[96:111], v[128:131], v[116:119], v[96:111]
    s_mov_b32 s62, 0x1c0000
    s_mov_b32 s63, 0x20000
    s_waitcnt lgkmcnt(5)
    v_mfma_f32_32x32x16_bf16 v[16:31], v[132:135], v[140:143], v[16:31]
    ds_read_b128 v[112:115], v154 offset:0
    ds_read_b128 v[120:123], v158 offset:0
    s_mov_b32 s64, s18
    s_and_b32 s65, s19, 0xffff
    s_mov_b32 s66, 0x80000
    s_waitcnt lgkmcnt(6)
    v_mfma_f32_32x32x16_bf16 v[32:47], v[136:139], v[140:143], v[32:47]
    ds_read_b128 v[116:119], v154 offset:4096
    ds_read_b64_tr_b16 v[124:125], v160 offset:8192
    s_mov_b32 s67, 0x20000
    s_mov_b32 s68, s20
    s_and_b32 s69, s21, 0xffff
    s_waitcnt lgkmcnt(6)
    v_mfma_f32_32x32x16_bf16 v[48:63], v[144:147], v[132:135], v[48:63]
    ds_read_b64_tr_b16 v[126:127], v160 offset:9216
    ds_read_b64_tr_b16 v[128:129], v161 offset:8192
    s_mov_b32 s70, 0x80000
    s_mov_b32 s71, 0x20000
    v_mfma_f32_32x32x16_bf16 v[64:79], v[144:147], v[136:139], v[64:79]
    ds_read_b64_tr_b16 v[130:131], v161 offset:9216
    s_lshl_b32 s78, s5, 15
    s_mul_i32 s76, s5, 458752
    s_lshl_b32 s86, s97, 7
    s_waitcnt lgkmcnt(7)
    v_mfma_f32_32x32x16_bf16 v[80:95], v[148:151], v[132:135], v[80:95]
    s_add_u32 s76, s76, s86
    s_lshl_b32 s77, s97, 16
    s_lshl_b32 s86, s5, 8
    v_mfma_f32_32x32x16_bf16 v[96:111], v[148:151], v[136:139], v[96:111]
    s_add_u32 s77, s77, s86
    v_lshrrev_b32 v15, 3, v1
    s_waitcnt lgkmcnt(5)
    v_mfma_f32_32x32x16_bf16 v[16:31], v[112:115], v[120:123], v[16:31]
    ds_read_b128 v[132:135], v155 offset:0
    ds_read_b128 v[140:143], v159 offset:0
    v_lshlrev_b32 v167, 10, v15
    v_bfe_u32 v15, v1, 4, 1
    v_bfe_u32 v11, v1, 2, 1
    s_waitcnt lgkmcnt(6)
    v_mfma_f32_32x32x16_bf16 v[32:47], v[116:119], v[120:123], v[32:47]
    ds_read_b128 v[136:139], v155 offset:4096
    ds_read_b64_tr_b16 v[144:145], v160 offset:12288
    v_xor_b32 v15, v15, v11
    v_lshl_add_u32 v167, v15, 6, v167
    v_and_b32 v15, 3, v1
    s_waitcnt lgkmcnt(6)
    v_mfma_f32_32x32x16_bf16 v[48:63], v[124:127], v[112:115], v[48:63]
    ds_read_b64_tr_b16 v[146:147], v160 offset:13312
    ds_read_b64_tr_b16 v[148:149], v161 offset:12288
    v_lshl_add_u32 v167, v15, 4, v167
    s_mov_b32 s72, s36
    v_mfma_f32_32x32x16_bf16 v[64:79], v[124:127], v[116:119], v[64:79]
    ds_read_b64_tr_b16 v[150:151], v161 offset:13312
    s_and_b32 s73, s37, 0xffff
    s_mov_b32 s74, 0x400000
    s_mov_b32 s75, 0x20000
    s_waitcnt lgkmcnt(7)
    v_mfma_f32_32x32x16_bf16 v[80:95], v[128:131], v[112:115], v[80:95]
    v_bfe_u32 v12, v1, 2, 2
    v_lshrrev_b32 v11, 5, v1
    v_lshl_add_u32 v10, v11, 2, v12
    v_mfma_f32_32x32x16_bf16 v[96:111], v[128:131], v[116:119], v[96:111]
    v_lshlrev_b32 v10, 7, v10
    v_bfe_u32 v11, v1, 4, 1
    s_waitcnt vmcnt(1) lgkmcnt(0)
    s_barrier
    v_mfma_f32_32x32x16_bf16 v[16:31], v[132:135], v[140:143], v[16:31]
    ds_read_b128 v[112:115], v152 offset:16384
    ds_read_b128 v[120:123], v156 offset:8192
    v_lshl_add_u32 v10, v11, 5, v10
    v_and_b32 v11, 3, v1
    v_lshl_add_u32 v10, v11, 3, v10
    v_mfma_f32_32x32x16_bf16 v[32:47], v[136:139], v[140:143], v[32:47]
    ds_read_b128 v[116:119], v152 offset:20480
    ds_read_b64_tr_b16 v[124:125], v160 offset:16384
    v_add_u32 v10, s78, v10
    v_lshrrev_b32 v12, 1, v12
    v_mfma_f32_32x32x16_bf16 v[48:63], v[144:147], v[132:135], v[48:63]
    ds_read_b64_tr_b16 v[126:127], v160 offset:17408
    ds_read_b64_tr_b16 v[128:129], v161 offset:16384
    v_lshl_add_u32 v232, v12, 6, v10
    v_xor_b32 v12, 1, v12
    v_lshl_add_u32 v233, v12, 6, v10
    v_mfma_f32_32x32x16_bf16 v[64:79], v[144:147], v[136:139], v[64:79]
    ds_read_b64_tr_b16 v[130:131], v161 offset:17408
    s_lshl_b32 s86, s6, 13
    s_sub_u32 s86, s78, s86
    v_add_u32 v234, s86, v152
    v_add_u32 v235, s86, v153
    v_add_u32 v236, s86, v154
    v_add_u32 v237, s86, v155
    v_lshlrev_b32 v238, 4, v1
    v_mfma_f32_32x32x16_bf16 v[80:95], v[148:151], v[132:135], v[80:95]
    s_lshl_b32 s86, s95, 1
    s_add_u32 s86, s86, s96
    s_mul_i32 s30, s86, 112
    s_mul_i32 s87, s5, 28
    s_add_u32 s30, s30, s87
    s_lshl_b32 s30, s30, 11
    s_lshl_b32 s31, s86, 6
    s_lshl_b32 s87, s5, 4
    s_add_u32 s31, s31, s87
    s_lshl_b32 s31, s31, 11
    s_add_u32 s31, s31, 8388608
    v_and_b32 v239, 15, v1
    s_lshl_b32 s86, s95, 4
    v_add_u32 v239, s86, v239
    v_mfma_f32_32x32x16_bf16 v[96:111], v[148:151], v[136:139], v[96:111]
    v_lshlrev_b32 v239, 7, v239
    v_bfe_u32 v12, v1, 2, 1
    s_waitcnt lgkmcnt(5)
    v_mfma_f32_32x32x16_bf16 v[16:31], v[112:115], v[120:123], v[16:31]
    ds_read_b128 v[132:135], v153 offset:16384
    ds_read_b128 v[140:143], v157 offset:8192
    v_lshlrev_b32 v11, 5, v12
    v_and_b32 v12, 1, v1
    v_lshl_add_u32 v11, v12, 3, v11
    s_waitcnt lgkmcnt(6)
    v_mfma_f32_32x32x16_bf16 v[32:47], v[116:119], v[120:123], v[32:47]
    ds_read_b128 v[136:139], v153 offset:20480
    ds_read_b64_tr_b16 v[144:145], v160 offset:20480
    v_bfe_u32 v12, v1, 4, 1
    v_lshl_add_u32 v11, v12, 2, v11
    v_bfe_u32 v12, v1, 3, 1
    s_waitcnt lgkmcnt(6)
    v_mfma_f32_32x32x16_bf16 v[48:63], v[124:127], v[112:115], v[48:63]
    ds_read_b64_tr_b16 v[146:147], v160 offset:21504
    ds_read_b64_tr_b16 v[148:149], v161 offset:20480
    v_lshl_add_u32 v11, v12, 1, v11
    v_bfe_u32 v12, v1, 1, 1
    v_mfma_f32_32x32x16_bf16 v[64:79], v[124:127], v[116:119], v[64:79]
    ds_read_b64_tr_b16 v[150:151], v161 offset:21504
    v_add_u32 v11, v11, v12
    s_lshl_b32 s86, s95, 7
    s_lshl_b32 s87, s96, 6
    s_add_u32 s86, s86, s87
    v_add_u32 v11, s86, v11
    v_lshlrev_b32 v11, 2, v11
    s_waitcnt lgkmcnt(7)
    v_mfma_f32_32x32x16_bf16 v[80:95], v[128:131], v[112:115], v[80:95]
    v_add_u32 v240, 12582912, v11
    s_lshl_b32 s86, s3, 1
    s_add_u32 s86, s86, s6
    s_mul_i32 s86, s86, 112
    s_lshr_b32 s87, s94, 4
    s_add_u32 s86, s86, s87
    s_lshl_b32 s87, s7, 2
    s_add_u32 s86, s86, s87
    s_lshl_b32 s86, s86, 11
    v_lshlrev_b32 v241, 4, v1
    v_add_u32 v241, s86, v241
    s_lshr_b32 s86, s4, 3
    s_and_b32 s86, s86, s7
    s_cmp_eq_u32 s86, 1
    s_cselect_b32 s86, 0x40000000, 0
    v_add_u32 v242, s86, v241
    v_mfma_f32_32x32x16_bf16 v[96:111], v[128:131], v[116:119], v[96:111]
    v_add_u32 v242, 4096, v242
    v_lshrrev_b32 v2, 4, v1
    s_waitcnt lgkmcnt(5)
    v_mfma_f32_32x32x16_bf16 v[16:31], v[132:135], v[140:143], v[16:31]
    ds_read_b128 v[112:115], v154 offset:16384
    ds_read_b128 v[120:123], v158 offset:8192
    s_lshl_b32 s86, s6, 2
    v_add_u32 v2, s86, v2
    v_and_b32 v3, 15, v1
    v_lshlrev_b32 v3, 3, v3
    s_waitcnt lgkmcnt(6)
    v_mfma_f32_32x32x16_bf16 v[32:47], v[136:139], v[140:143], v[32:47]
    ds_read_b128 v[116:119], v154 offset:20480
    ds_read_b64_tr_b16 v[124:125], v160 offset:24576
    s_lshl_b32 s86, s7, 10
    s_add_u32 s86, s86, 147456
    v_add_u32 v244, s86, v3
    v_lshl_add_u32 v243, v2, 7, v244
    s_lshl_b32 s86, s3, 4
    s_add_u32 s86, s86, s4
    s_lshl_b32 s86, s86, 1
    s_add_u32 s86, s86, s7
    s_lshl_b32 s86, s86, 8
    s_add_u32 s86, s86, 12648448
    v_and_b32 v5, 15, v1
    v_lshlrev_b32 v5, 4, v5
    v_add_u32 v5, s86, v5
    s_waitcnt lgkmcnt(6)
    v_mfma_f32_32x32x16_bf16 v[48:63], v[144:147], v[132:135], v[48:63]
    ds_read_b64_tr_b16 v[126:127], v160 offset:25600
    ds_read_b64_tr_b16 v[128:129], v161 offset:24576
    v_lshrrev_b32 v6, 4, v1
    v_mov_b32 v8, 0x40000000
    v_mfma_f32_32x32x16_bf16 v[64:79], v[144:147], v[136:139], v[64:79]
    ds_read_b64_tr_b16 v[130:131], v161 offset:25600
    v_add_u32 v7, 1, v6
    v_cmp_ge_u32 vcc, s3, v7
    v_lshlrev_b32 v7, 13, v7
    v_sub_u32 v7, v5, v7
    v_cndmask_b32 v245, v8, v7, vcc
    v_add_u32 v7, 5, v6
    v_cmp_ge_u32 vcc, s3, v7
    v_lshlrev_b32 v7, 13, v7
    v_sub_u32 v7, v5, v7
    v_cndmask_b32 v246, v8, v7, vcc
    v_add_u32 v7, 9, v6
    v_cmp_ge_u32 vcc, s3, v7
    v_lshlrev_b32 v7, 13, v7
    v_sub_u32 v7, v5, v7
    v_cndmask_b32 v247, v8, v7, vcc
    s_waitcnt lgkmcnt(7)
    v_mfma_f32_32x32x16_bf16 v[80:95], v[148:151], v[132:135], v[80:95]
    v_add_u32 v7, 13, v6
    v_cmp_ge_u32 vcc, s3, v7
    v_lshlrev_b32 v7, 13, v7
    v_sub_u32 v7, v5, v7
    v_cndmask_b32 v248, v8, v7, vcc
    v_bfe_u32 v2, v1, 4, 1
    v_lshrrev_b32 v3, 5, v1
    v_mfma_f32_32x32x16_bf16 v[96:111], v[148:151], v[136:139], v[96:111]
    v_lshlrev_b32 v4, 5, v2
    v_lshl_add_u32 v4, v3, 2, v4
    s_waitcnt lgkmcnt(5)
    v_mfma_f32_32x32x16_bf16 v[16:31], v[112:115], v[120:123], v[16:31]
    ds_read_b128 v[132:135], v155 offset:16384
    ds_read_b128 v[140:143], v159 offset:8192
    v_lshlrev_b32 v4, 6, v4
    s_lshl_b32 s87, s5, 12
    s_add_u32 s87, s87, 131072
    v_add_u32 v4, s87, v4
    v_and_b32 v15, 31, v1
    v_lshlrev_b32 v9, 6, v15
    v_add_u32 v9, s87, v9
    v_and_b32 v5, 3, v1
    s_waitcnt lgkmcnt(6)
    v_mfma_f32_32x32x16_bf16 v[32:47], v[116:119], v[120:123], v[32:47]
    ds_read_b128 v[136:139], v155 offset:20480
    ds_read_b64_tr_b16 v[144:145], v160 offset:28672
    v_lshl_add_u32 v4, v5, 2, v4
    v_bfe_u32 v5, v1, 2, 2
    v_xor_b32 v5, v5, v3
    s_waitcnt lgkmcnt(6)
    v_mfma_f32_32x32x16_bf16 v[48:63], v[124:127], v[112:115], v[48:63]
    ds_read_b64_tr_b16 v[146:147], v160 offset:29696
    ds_read_b64_tr_b16 v[148:149], v161 offset:28672
    v_lshl_add_u32 v252, v5, 4, v4
    v_xor_b32 v5, 2, v5
    v_mfma_f32_32x32x16_bf16 v[64:79], v[124:127], v[116:119], v[64:79]
    ds_read_b64_tr_b16 v[150:151], v161 offset:29696
    v_lshl_add_u32 v253, v5, 4, v4
    v_bfe_u32 v5, v15, 2, 2
    v_lshlrev_b32 v8, 1, v3
    s_waitcnt lgkmcnt(7)
    v_mfma_f32_32x32x16_bf16 v[80:95], v[128:131], v[112:115], v[80:95]
    v_xor_b32 v5, v5, v8
    v_lshl_add_u32 v254, v5, 4, v9
    v_xor_b32 v5, 1, v5
    v_mfma_f32_32x32x16_bf16 v[96:111], v[128:131], v[116:119], v[96:111]
    v_lshl_add_u32 v255, v5, 4, v9
    s_lshl_b32 s86, s3, 1
    s_add_u32 s86, s86, s6
    s_lshl_b32 s86, s86, 6
    s_lshl_b32 s87, s4, 2
    s_add_u32 s86, s86, s87
    s_lshl_b32 s87, s7, 1
    s_add_u32 s86, s86, s87
    s_lshl_b32 s86, s86, 11
    s_add_u32 s86, s86, 8388608
    v_lshlrev_b32 v5, 4, v1
    v_add_u32 v249, s86, v5
    s_waitcnt lgkmcnt(0)
    s_barrier
    v_mfma_f32_32x32x16_bf16 v[16:31], v[132:135], v[140:143], v[16:31]
    s_add_u32 m0, s78, 0
    s_add_u32 s2, s76, 0
    buffer_load_dwordx4 v167, s[60:63], s2 offen offset:0 lds
    v_mfma_f32_32x32x16_bf16 v[32:47], v[136:139], v[140:143], v[32:47]
    v_mfma_f32_32x32x16_bf16 v[48:63], v[144:147], v[132:135], v[48:63]
    s_add_u32 s2, s76, 7168
    buffer_load_dwordx4 v167, s[60:63], s2 offen offset:1024 lds
    v_mfma_f32_32x32x16_bf16 v[64:79], v[144:147], v[136:139], v[64:79]
    v_mfma_f32_32x32x16_bf16 v[80:95], v[148:151], v[132:135], v[80:95]
    s_add_u32 s2, s76, 14336
    buffer_load_dwordx4 v167, s[60:63], s2 offen offset:2048 lds
    v_mfma_f32_32x32x16_bf16 v[96:111], v[148:151], v[136:139], v[96:111]
    s_waitcnt vmcnt(3)
    v_readfirstlane_b32 s90, v14
    s_nop 0
    s_cmp_lg_u32 s90, 0
    s_cbranch_scc1 nonce_ok_4
    s_mov_b32 s100, 0
nonce_3:
    global_load_dword v14, v13, s[38:39] sc1
    s_waitcnt vmcnt(0)
    v_readfirstlane_b32 s90, v14
    s_add_u32 s100, s100, 1
    s_cmp_gt_u32 s100, 200000
    s_cbranch_scc1 nonce_ok_4
    s_cmp_eq_u32 s90, 0
    s_cbranch_scc1 nonce_3
nonce_ok_4:
    s_xor_b32 s91, s90, 0x5bd1e995
    v_pk_mul_f32 v[196:197], v[48:49], s[92:93] op_sel_hi:[1,0]
    v_pk_mul_f32 v[198:199], v[50:51], s[92:93] op_sel_hi:[1,0]
    v_pk_mul_f32 v[200:201], v[52:53], s[92:93] op_sel_hi:[1,0]
    v_pk_mul_f32 v[202:203], v[54:55], s[92:93] op_sel_hi:[1,0]
    v_pk_mul_f32 v[204:205], v[56:57], s[92:93] op_sel_hi:[1,0]
    v_pk_mul_f32 v[206:207], v[58:59], s[92:93] op_sel_hi:[1,0]
    v_pk_mul_f32 v[208:209], v[60:61], s[92:93] op_sel_hi:[1,0]
    v_pk_mul_f32 v[210:211], v[62:63], s[92:93] op_sel_hi:[1,0]
    v_exp_f32 v196, v196
    v_exp_f32 v197, v197
    v_exp_f32 v198, v198
    v_exp_f32 v199, v199
    v_exp_f32 v200, v200
    s_add_u32 s2, s76, 21504
    buffer_load_dwordx4 v167, s[60:63], s2 offen offset:3072 lds
    v_exp_f32 v201, v201
    v_exp_f32 v202, v202
    v_exp_f32 v203, v203
    v_exp_f32 v204, v204
    v_exp_f32 v205, v205
    v_exp_f32 v206, v206
    v_exp_f32 v207, v207
    v_exp_f32 v208, v208
    v_exp_f32 v209, v209
    s_add_u32 m0, s78, 4096
    s_add_u32 s2, s76, 32768
    buffer_load_dwordx4 v167, s[60:63], s2 offen offset:0 lds
    v_exp_f32 v210, v210
    v_exp_f32 v211, v211
    v_pk_add_f32 v[212:213], v[196:197], 2.0 op_sel_hi:[1,0]
    v_pk_add_f32 v[214:215], v[198:199], 2.0 op_sel_hi:[1,0]
    v_pk_add_f32 v[216:217], v[200:201], 2.0 op_sel_hi:[1,0]
    v_pk_add_f32 v[218:219], v[202:203], 2.0 op_sel_hi:[1,0]
    v_pk_add_f32 v[220:221], v[204:205], 2.0 op_sel_hi:[1,0]
    v_pk_add_f32 v[222:223], v[206:207], 2.0 op_sel_hi:[1,0]
    v_pk_add_f32 v[224:225], v[208:209], 2.0 op_sel_hi:[1,0]
    v_pk_add_f32 v[226:227], v[210:211], 2.0 op_sel_hi:[1,0]
    v_pk_fma_f32 v[196:197], v[196:197], v[212:213], 2.0 op_sel_hi:[1,1,0]
    v_pk_fma_f32 v[198:199], v[198:199], v[214:215], 2.0 op_sel_hi:[1,1,0]
    v_pk_fma_f32 v[200:201], v[200:201], v[216:217], 2.0 op_sel_hi:[1,1,0]
    v_pk_fma_f32 v[202:203], v[202:203], v[218:219], 2.0 op_sel_hi:[1,1,0]
    v_pk_fma_f32 v[204:205], v[204:205], v[220:221], 2.0 op_sel_hi:[1,1,0]
    v_pk_fma_f32 v[206:207], v[206:207], v[222:223], 2.0 op_sel_hi:[1,1,0]
    s_add_u32 s2, s76, 39936
    buffer_load_dwordx4 v167, s[60:63], s2 offen offset:1024 lds
    v_pk_fma_f32 v[208:209], v[208:209], v[224:225], 2.0 op_sel_hi:[1,1,0]
    v_pk_fma_f32 v[210:211], v[210:211], v[226:227], 2.0 op_sel_hi:[1,1,0]
    v_rcp_f32 v196, v196
    v_rcp_f32 v197, v197
    v_rcp_f32 v198, v198
    v_rcp_f32 v199, v199
    v_rcp_f32 v200, v200
    v_rcp_f32 v201, v201
    v_rcp_f32 v202, v202
    v_rcp_f32 v203, v203
    s_add_u32 s2, s76, 47104
    buffer_load_dwordx4 v167, s[60:63], s2 offen offset:2048 lds
    v_rcp_f32 v204, v204
    v_rcp_f32 v205, v205
    v_rcp_f32 v206, v206
    v_rcp_f32 v207, v207
    v_rcp_f32 v208, v208
    v_rcp_f32 v209, v209
    v_rcp_f32 v210, v210
    v_rcp_f32 v211, v211
    v_pk_fma_f32 v[196:197], v[196:197], -2.0, 1.0 op_sel_hi:[1,0,0]
    v_pk_fma_f32 v[198:199], v[198:199], -2.0, 1.0 op_sel_hi:[1,0,0]
    s_add_u32 s2, s76, 54272
    buffer_load_dwordx4 v167, s[60:63], s2 offen offset:3072 lds
    v_pk_fma_f32 v[200:201], v[200:201], -2.0, 1.0 op_sel_hi:[1,0,0]
    v_pk_fma_f32 v[202:203], v[202:203], -2.0, 1.0 op_sel_hi:[1,0,0]
    v_pk_fma_f32 v[204:205], v[204:205], -2.0, 1.0 op_sel_hi:[1,0,0]
    v_pk_fma_f32 v[206:207], v[206:207], -2.0, 1.0 op_sel_hi:[1,0,0]
    v_pk_fma_f32 v[208:209], v[208:209], -2.0, 1.0 op_sel_hi:[1,0,0]
    v_pk_fma_f32 v[210:211], v[210:211], -2.0, 1.0 op_sel_hi:[1,0,0]
    v_pk_mul_f32 v[48:49], v[48:49], v[196:197]
    v_pk_mul_f32 v[50:51], v[50:51], v[198:199]
    v_pk_mul_f32 v[52:53], v[52:53], v[200:201]
    v_pk_mul_f32 v[54:55], v[54:55], v[202:203]
    v_pk_mul_f32 v[56:57], v[56:57], v[204:205]
    v_pk_mul_f32 v[58:59], v[58:59], v[206:207]
    v_pk_mul_f32 v[60:61], v[60:61], v[208:209]
    v_pk_mul_f32 v[62:63], v[62:63], v[210:211]
    v_cvt_pk_bf16_f32 v112, v48, v49
    v_cvt_pk_bf16_f32 v113, v50, v51
    v_cvt_pk_bf16_f32 v114, v52, v53
    v_cvt_pk_bf16_f32 v115, v54, v55
    s_add_u32 m0, s78, 8192
    s_add_u32 s2, s76, 65536
    buffer_load_dwordx4 v167, s[60:63], s2 offen offset:0 lds
    v_cvt_pk_bf16_f32 v116, v56, v57
    v_cvt_pk_bf16_f32 v117, v58, v59
    v_cvt_pk_bf16_f32 v118, v60, v61
    v_cvt_pk_bf16_f32 v119, v62, v63
    buffer_store_dwordx4 v[112:115], v241, s[56:59], 0 offen offset:0 sc1
    buffer_store_dwordx4 v[116:119], v241, s[56:59], 0 offen offset:2048 sc1
    v_pk_mul_f32 v[196:197], v[64:65], s[92:93] op_sel_hi:[1,0]
    v_pk_mul_f32 v[198:199], v[66:67], s[92:93] op_sel_hi:[1,0]
    v_pk_mul_f32 v[200:201], v[68:69], s[92:93] op_sel_hi:[1,0]
    v_pk_mul_f32 v[202:203], v[70:71], s[92:93] op_sel_hi:[1,0]
    v_pk_mul_f32 v[204:205], v[72:73], s[92:93] op_sel_hi:[1,0]
    v_pk_mul_f32 v[206:207], v[74:75], s[92:93] op_sel_hi:[1,0]
    v_pk_mul_f32 v[208:209], v[76:77], s[92:93] op_sel_hi:[1,0]
    v_pk_mul_f32 v[210:211], v[78:79], s[92:93] op_sel_hi:[1,0]
    v_exp_f32 v196, v196
    v_exp_f32 v197, v197
    v_exp_f32 v198, v198
    v_exp_f32 v199, v199
    v_exp_f32 v200, v200
    s_add_u32 s2, s76, 72704
    buffer_load_dwordx4 v167, s[60:63], s2 offen offset:1024 lds
    v_exp_f32 v201, v201
    v_exp_f32 v202, v202
    v_exp_f32 v203, v203
    v_exp_f32 v204, v204
    v_exp_f32 v205, v205
    v_exp_f32 v206, v206
    v_exp_f32 v207, v207
    v_exp_f32 v208, v208
    v_exp_f32 v209, v209
    s_add_u32 s2, s76, 79872
    buffer_load_dwordx4 v167, s[60:63], s2 offen offset:2048 lds
    v_exp_f32 v210, v210
    v_exp_f32 v211, v211
    v_pk_add_f32 v[212:213], v[196:197], 2.0 op_sel_hi:[1,0]
    v_pk_add_f32 v[214:215], v[198:199], 2.0 op_sel_hi:[1,0]
    v_pk_add_f32 v[216:217], v[200:201], 2.0 op_sel_hi:[1,0]
    v_pk_add_f32 v[218:219], v[202:203], 2.0 op_sel_hi:[1,0]
    v_pk_add_f32 v[220:221], v[204:205], 2.0 op_sel_hi:[1,0]
    v_pk_add_f32 v[222:223], v[206:207], 2.0 op_sel_hi:[1,0]
    v_pk_add_f32 v[224:225], v[208:209], 2.0 op_sel_hi:[1,0]
    v_pk_add_f32 v[226:227], v[210:211], 2.0 op_sel_hi:[1,0]
    v_pk_fma_f32 v[196:197], v[196:197], v[212:213], 2.0 op_sel_hi:[1,1,0]
    v_pk_fma_f32 v[198:199], v[198:199], v[214:215], 2.0 op_sel_hi:[1,1,0]
    v_pk_fma_f32 v[200:201], v[200:201], v[216:217], 2.0 op_sel_hi:[1,1,0]
    v_pk_fma_f32 v[202:203], v[202:203], v[218:219], 2.0 op_sel_hi:[1,1,0]
    v_pk_fma_f32 v[204:205], v[204:205], v[220:221], 2.0 op_sel_hi:[1,1,0]
    v_pk_fma_f32 v[206:207], v[206:207], v[222:223], 2.0 op_sel_hi:[1,1,0]
    s_add_u32 s2, s76, 87040
    buffer_load_dwordx4 v167, s[60:63], s2 offen offset:3072 lds
    v_pk_fma_f32 v[208:209], v[208:209], v[224:225], 2.0 op_sel_hi:[1,1,0]
    v_pk_fma_f32 v[210:211], v[210:211], v[226:227], 2.0 op_sel_hi:[1,1,0]
    v_rcp_f32 v196, v196
    v_rcp_f32 v197, v197
    v_rcp_f32 v198, v198
    v_rcp_f32 v199, v199
    v_rcp_f32 v200, v200
    v_rcp_f32 v201, v201
    v_rcp_f32 v202, v202
    v_rcp_f32 v203, v203
    s_add_u32 m0, s78, 12288
    s_add_u32 s2, s76, 98304
    buffer_load_dwordx4 v167, s[60:63], s2 offen offset:0 lds
    v_rcp_f32 v204, v204
    v_rcp_f32 v205, v205
    v_rcp_f32 v206, v206
    v_rcp_f32 v207, v207
    v_rcp_f32 v208, v208
    v_rcp_f32 v209, v209
    v_rcp_f32 v210, v210
    v_rcp_f32 v211, v211
    v_pk_fma_f32 v[196:197], v[196:197], -2.0, 1.0 op_sel_hi:[1,0,0]
    v_pk_fma_f32 v[198:199], v[198:199], -2.0, 1.0 op_sel_hi:[1,0,0]
    s_add_u32 s2, s76, 105472
    buffer_load_dwordx4 v167, s[60:63], s2 offen offset:1024 lds
    v_pk_fma_f32 v[200:201], v[200:201], -2.0, 1.0 op_sel_hi:[1,0,0]
    v_pk_fma_f32 v[202:203], v[202:203], -2.0, 1.0 op_sel_hi:[1,0,0]
    v_pk_fma_f32 v[204:205], v[204:205], -2.0, 1.0 op_sel_hi:[1,0,0]
    v_pk_fma_f32 v[206:207], v[206:207], -2.0, 1.0 op_sel_hi:[1,0,0]
    v_pk_fma_f32 v[208:209], v[208:209], -2.0, 1.0 op_sel_hi:[1,0,0]
    v_pk_fma_f32 v[210:211], v[210:211], -2.0, 1.0 op_sel_hi:[1,0,0]
    v_pk_mul_f32 v[64:65], v[64:65], v[196:197]
    v_pk_mul_f32 v[66:67], v[66:67], v[198:199]
    v_pk_mul_f32 v[68:69], v[68:69], v[200:201]
    v_pk_mul_f32 v[70:71], v[70:71], v[202:203]
    v_pk_mul_f32 v[72:73], v[72:73], v[204:205]
    v_pk_mul_f32 v[74:75], v[74:75], v[206:207]
    v_pk_mul_f32 v[76:77], v[76:77], v[208:209]
    v_pk_mul_f32 v[78:79], v[78:79], v[210:211]
    v_cvt_pk_bf16_f32 v120, v64, v65
    v_cvt_pk_bf16_f32 v121, v66, v67
    v_cvt_pk_bf16_f32 v122, v68, v69
    v_cvt_pk_bf16_f32 v123, v70, v71
    s_add_u32 s2, s76, 112640
    buffer_load_dwordx4 v167, s[60:63], s2 offen offset:2048 lds
    v_cvt_pk_bf16_f32 v124, v72, v73
    v_cvt_pk_bf16_f32 v125, v74, v75
    v_cvt_pk_bf16_f32 v126, v76, v77
    v_cvt_pk_bf16_f32 v127, v78, v79
    buffer_store_dwordx4 v[120:123], v241, s[56:59], 0 offen offset:1024 sc1
    buffer_store_dwordx4 v[124:127], v241, s[56:59], 0 offen offset:3072 sc1
    v_pk_mul_f32 v[196:197], v[80:81], s[92:93] op_sel_hi:[1,0]
    v_pk_mul_f32 v[198:199], v[82:83], s[92:93] op_sel_hi:[1,0]
    v_pk_mul_f32 v[200:201], v[84:85], s[92:93] op_sel_hi:[1,0]
    v_pk_mul_f32 v[202:203], v[86:87], s[92:93] op_sel_hi:[1,0]
    v_pk_mul_f32 v[204:205], v[88:89], s[92:93] op_sel_hi:[1,0]
    v_pk_mul_f32 v[206:207], v[90:91], s[92:93] op_sel_hi:[1,0]
    v_pk_mul_f32 v[208:209], v[92:93], s[92:93] op_sel_hi:[1,0]
    v_pk_mul_f32 v[210:211], v[94:95], s[92:93] op_sel_hi:[1,0]
    v_exp_f32 v196, v196
    v_exp_f32 v197, v197
    v_exp_f32 v198, v198
    v_exp_f32 v199, v199
    v_exp_f32 v200, v200
    s_add_u32 s2, s76, 119808
    buffer_load_dwordx4 v167, s[60:63], s2 offen offset:3072 lds
    v_exp_f32 v201, v201
    v_exp_f32 v202, v202
    v_exp_f32 v203, v203
    v_exp_f32 v204, v204
    v_exp_f32 v205, v205
    v_exp_f32 v206, v206
    v_exp_f32 v207, v207
    v_exp_f32 v208, v208
    v_exp_f32 v209, v209
    s_add_u32 m0, s78, 16384
    s_add_u32 s2, s76, 131072
    buffer_load_dwordx4 v167, s[60:63], s2 offen offset:0 lds
    v_exp_f32 v210, v210
    v_exp_f32 v211, v211
    v_pk_add_f32 v[212:213], v[196:197], 2.0 op_sel_hi:[1,0]
    v_pk_add_f32 v[214:215], v[198:199], 2.0 op_sel_hi:[1,0]
    v_pk_add_f32 v[216:217], v[200:201], 2.0 op_sel_hi:[1,0]
    v_pk_add_f32 v[218:219], v[202:203], 2.0 op_sel_hi:[1,0]
    v_pk_add_f32 v[220:221], v[204:205], 2.0 op_sel_hi:[1,0]
    v_pk_add_f32 v[222:223], v[206:207], 2.0 op_sel_hi:[1,0]
    v_pk_add_f32 v[224:225], v[208:209], 2.0 op_sel_hi:[1,0]
    v_pk_add_f32 v[226:227], v[210:211], 2.0 op_sel_hi:[1,0]
    v_pk_fma_f32 v[196:197], v[196:197], v[212:213], 2.0 op_sel_hi:[1,1,0]
    v_pk_fma_f32 v[198:199], v[198:199], v[214:215], 2.0 op_sel_hi:[1,1,0]
    v_pk_fma_f32 v[200:201], v[200:201], v[216:217], 2.0 op_sel_hi:[1,1,0]
    v_pk_fma_f32 v[202:203], v[202:203], v[218:219], 2.0 op_sel_hi:[1,1,0]
    v_pk_fma_f32 v[204:205], v[204:205], v[220:221], 2.0 op_sel_hi:[1,1,0]
    v_pk_fma_f32 v[206:207], v[206:207], v[222:223], 2.0 op_sel_hi:[1,1,0]
    s_add_u32 s2, s76, 138240
    buffer_load_dwordx4 v167, s[60:63], s2 offen offset:1024 lds
    v_pk_fma_f32 v[208:209], v[208:209], v[224:225], 2.0 op_sel_hi:[1,1,0]
    v_pk_fma_f32 v[210:211], v[210:211], v[226:227], 2.0 op_sel_hi:[1,1,0]
    v_rcp_f32 v196, v196
    v_rcp_f32 v197, v197
    v_rcp_f32 v198, v198
    v_rcp_f32 v199, v199
    v_rcp_f32 v200, v200
    v_rcp_f32 v201, v201
    v_rcp_f32 v202, v202
    v_rcp_f32 v203, v203
    s_add_u32 s2, s76, 145408
    buffer_load_dwordx4 v167, s[60:63], s2 offen offset:2048 lds
    v_rcp_f32 v204, v204
    v_rcp_f32 v205, v205
    v_rcp_f32 v206, v206
    v_rcp_f32 v207, v207
    v_rcp_f32 v208, v208
    v_rcp_f32 v209, v209
    v_rcp_f32 v210, v210
    v_rcp_f32 v211, v211
    v_pk_fma_f32 v[196:197], v[196:197], -2.0, 1.0 op_sel_hi:[1,0,0]
    v_pk_fma_f32 v[198:199], v[198:199], -2.0, 1.0 op_sel_hi:[1,0,0]
    s_add_u32 s2, s76, 152576
    buffer_load_dwordx4 v167, s[60:63], s2 offen offset:3072 lds
    v_pk_fma_f32 v[200:201], v[200:201], -2.0, 1.0 op_sel_hi:[1,0,0]
    v_pk_fma_f32 v[202:203], v[202:203], -2.0, 1.0 op_sel_hi:[1,0,0]
    v_pk_fma_f32 v[204:205], v[204:205], -2.0, 1.0 op_sel_hi:[1,0,0]
    v_pk_fma_f32 v[206:207], v[206:207], -2.0, 1.0 op_sel_hi:[1,0,0]
    v_pk_fma_f32 v[208:209], v[208:209], -2.0, 1.0 op_sel_hi:[1,0,0]
    v_pk_fma_f32 v[210:211], v[210:211], -2.0, 1.0 op_sel_hi:[1,0,0]
    v_pk_mul_f32 v[80:81], v[80:81], v[196:197]
    v_pk_mul_f32 v[82:83], v[82:83], v[198:199]
    v_pk_mul_f32 v[84:85], v[84:85], v[200:201]
    v_pk_mul_f32 v[86:87], v[86:87], v[202:203]
    v_pk_mul_f32 v[88:89], v[88:89], v[204:205]
    v_pk_mul_f32 v[90:91], v[90:91], v[206:207]
    v_pk_mul_f32 v[92:93], v[92:93], v[208:209]
    v_pk_mul_f32 v[94:95], v[94:95], v[210:211]
    v_cvt_pk_bf16_f32 v112, v80, v81
    v_cvt_pk_bf16_f32 v113, v82, v83
    v_cvt_pk_bf16_f32 v114, v84, v85
    v_cvt_pk_bf16_f32 v115, v86, v87
    s_add_u32 m0, s78, 20480
    s_add_u32 s2, s76, 163840
    buffer_load_dwordx4 v167, s[60:63], s2 offen offset:0 lds
    v_cvt_pk_bf16_f32 v116, v88, v89
    v_cvt_pk_bf16_f32 v117, v90, v91
    v_cvt_pk_bf16_f32 v118, v92, v93
    v_cvt_pk_bf16_f32 v119, v94, v95
    buffer_store_dwordx4 v[112:115], v242, s[56:59], 0 offen offset:0 sc1
    buffer_store_dwordx4 v[116:119], v242, s[56:59], 0 offen offset:2048 sc1
    v_pk_mul_f32 v[196:197], v[96:97], s[92:93] op_sel_hi:[1,0]
    v_pk_mul_f32 v[198:199], v[98:99], s[92:93] op_sel_hi:[1,0]
    v_pk_mul_f32 v[200:201], v[100:101], s[92:93] op_sel_hi:[1,0]
    v_pk_mul_f32 v[202:203], v[102:103], s[92:93] op_sel_hi:[1,0]
    v_pk_mul_f32 v[204:205], v[104:105], s[92:93] op_sel_hi:[1,0]
    v_pk_mul_f32 v[206:207], v[106:107], s[92:93] op_sel_hi:[1,0]
    v_pk_mul_f32 v[208:209], v[108:109], s[92:93] op_sel_hi:[1,0]
    v_pk_mul_f32 v[210:211], v[110:111], s[92:93] op_sel_hi:[1,0]
    v_exp_f32 v196, v196
    v_exp_f32 v197, v197
    v_exp_f32 v198, v198
    v_exp_f32 v199, v199
    v_exp_f32 v200, v200
    s_add_u32 s2, s76, 171008
    buffer_load_dwordx4 v167, s[60:63], s2 offen offset:1024 lds
    s_waitcnt vmcnt(26)
    ds_read_b64_tr_b16 a[0:1], v232 offset:0
    ds_read_b64_tr_b16 a[2:3], v232 offset:1024
    ds_read_b64_tr_b16 a[4:5], v233 offset:0
    ds_read_b64_tr_b16 a[6:7], v233 offset:1024
    v_exp_f32 v201, v201
    v_exp_f32 v202, v202
    v_exp_f32 v203, v203
    v_exp_f32 v204, v204
    v_exp_f32 v205, v205
    v_exp_f32 v206, v206
    v_exp_f32 v207, v207
    v_exp_f32 v208, v208
    v_exp_f32 v209, v209
    s_add_u32 s2, s76, 178176
    buffer_load_dwordx4 v167, s[60:63], s2 offen offset:2048 lds
    v_exp_f32 v210, v210
    v_exp_f32 v211, v211
    v_pk_add_f32 v[212:213], v[196:197], 2.0 op_sel_hi:[1,0]
    v_pk_add_f32 v[214:215], v[198:199], 2.0 op_sel_hi:[1,0]
    v_pk_add_f32 v[216:217], v[200:201], 2.0 op_sel_hi:[1,0]
    v_pk_add_f32 v[218:219], v[202:203], 2.0 op_sel_hi:[1,0]
    v_pk_add_f32 v[220:221], v[204:205], 2.0 op_sel_hi:[1,0]
    v_pk_add_f32 v[222:223], v[206:207], 2.0 op_sel_hi:[1,0]
    v_pk_add_f32 v[224:225], v[208:209], 2.0 op_sel_hi:[1,0]
    v_pk_add_f32 v[226:227], v[210:211], 2.0 op_sel_hi:[1,0]
    v_pk_fma_f32 v[196:197], v[196:197], v[212:213], 2.0 op_sel_hi:[1,1,0]
    v_pk_fma_f32 v[198:199], v[198:199], v[214:215], 2.0 op_sel_hi:[1,1,0]
    v_pk_fma_f32 v[200:201], v[200:201], v[216:217], 2.0 op_sel_hi:[1,1,0]
    v_pk_fma_f32 v[202:203], v[202:203], v[218:219], 2.0 op_sel_hi:[1,1,0]
    v_pk_fma_f32 v[204:205], v[204:205], v[220:221], 2.0 op_sel_hi:[1,1,0]
    v_pk_fma_f32 v[206:207], v[206:207], v[222:223], 2.0 op_sel_hi:[1,1,0]
    s_add_u32 s2, s76, 185344
    buffer_load_dwordx4 v167, s[60:63], s2 offen offset:3072 lds
    s_waitcnt vmcnt(26)
    ds_read_b64_tr_b16 a[8:9], v232 offset:2048
    ds_read_b64_tr_b16 a[10:11], v232 offset:3072
    ds_read_b64_tr_b16 a[12:13], v233 offset:2048
    ds_read_b64_tr_b16 a[14:15], v233 offset:3072
    v_pk_fma_f32 v[208:209], v[208:209], v[224:225], 2.0 op_sel_hi:[1,1,0]
    v_pk_fma_f32 v[210:211], v[210:211], v[226:227], 2.0 op_sel_hi:[1,1,0]
    v_rcp_f32 v196, v196
    v_rcp_f32 v197, v197
    v_rcp_f32 v198, v198
    v_rcp_f32 v199, v199
    v_rcp_f32 v200, v200
    v_rcp_f32 v201, v201
    v_rcp_f32 v202, v202
    v_rcp_f32 v203, v203
    s_add_u32 m0, s78, 24576
    s_add_u32 s2, s76, 196608
    buffer_load_dwordx4 v167, s[60:63], s2 offen offset:0 lds
    v_rcp_f32 v204, v204
    v_rcp_f32 v205, v205
    v_rcp_f32 v206, v206
    v_rcp_f32 v207, v207
    v_rcp_f32 v208, v208
    v_rcp_f32 v209, v209
    v_rcp_f32 v210, v210
    v_rcp_f32 v211, v211
    v_pk_fma_f32 v[196:197], v[196:197], -2.0, 1.0 op_sel_hi:[1,0,0]
    v_pk_fma_f32 v[198:199], v[198:199], -2.0, 1.0 op_sel_hi:[1,0,0]
    s_add_u32 s2, s76, 203776
    buffer_load_dwordx4 v167, s[60:63], s2 offen offset:1024 lds
    s_waitcnt vmcnt(26)
    ds_read_b64_tr_b16 a[16:17], v232 offset:4096
    ds_read_b64_tr_b16 a[18:19], v232 offset:5120
    ds_read_b64_tr_b16 a[20:21], v233 offset:4096
    ds_read_b64_tr_b16 a[22:23], v233 offset:5120
    v_pk_fma_f32 v[200:201], v[200:201], -2.0, 1.0 op_sel_hi:[1,0,0]
    v_pk_fma_f32 v[202:203], v[202:203], -2.0, 1.0 op_sel_hi:[1,0,0]
    v_pk_fma_f32 v[204:205], v[204:205], -2.0, 1.0 op_sel_hi:[1,0,0]
    v_pk_fma_f32 v[206:207], v[206:207], -2.0, 1.0 op_sel_hi:[1,0,0]
    v_pk_fma_f32 v[208:209], v[208:209], -2.0, 1.0 op_sel_hi:[1,0,0]
    v_pk_fma_f32 v[210:211], v[210:211], -2.0, 1.0 op_sel_hi:[1,0,0]
    v_pk_mul_f32 v[96:97], v[96:97], v[196:197]
    v_pk_mul_f32 v[98:99], v[98:99], v[198:199]
    v_pk_mul_f32 v[100:101], v[100:101], v[200:201]
    v_pk_mul_f32 v[102:103], v[102:103], v[202:203]
    v_pk_mul_f32 v[104:105], v[104:105], v[204:205]
    v_pk_mul_f32 v[106:107], v[106:107], v[206:207]
    v_pk_mul_f32 v[108:109], v[108:109], v[208:209]
    v_pk_mul_f32 v[110:111], v[110:111], v[210:211]
    v_cvt_pk_bf16_f32 v120, v96, v97
    v_cvt_pk_bf16_f32 v121, v98, v99
    v_cvt_pk_bf16_f32 v122, v100, v101
    v_cvt_pk_bf16_f32 v123, v102, v103
    s_add_u32 s2, s76, 210944
    buffer_load_dwordx4 v167, s[60:63], s2 offen offset:2048 lds
    v_cvt_pk_bf16_f32 v124, v104, v105
    v_cvt_pk_bf16_f32 v125, v106, v107
    v_cvt_pk_bf16_f32 v126, v108, v109
    v_cvt_pk_bf16_f32 v127, v110, v111
    buffer_store_dwordx4 v[120:123], v242, s[56:59], 0 offen offset:1024 sc1
    buffer_store_dwordx4 v[124:127], v242, s[56:59], 0 offen offset:3072 sc1
    s_add_u32 s2, s76, 218112
    buffer_load_dwordx4 v167, s[60:63], s2 offen offset:3072 lds
    s_waitcnt vmcnt(28)
    ds_read_b64_tr_b16 a[24:25], v232 offset:6144
    ds_read_b64_tr_b16 a[26:27], v232 offset:7168
    ds_read_b64_tr_b16 a[28:29], v233 offset:6144
    ds_read_b64_tr_b16 a[30:31], v233 offset:7168
    s_add_u32 m0, s78, 28672
    s_add_u32 s2, s76, 229376
    buffer_load_dwordx4 v167, s[60:63], s2 offen offset:0 lds
    s_add_u32 s2, s76, 236544
    buffer_load_dwordx4 v167, s[60:63], s2 offen offset:1024 lds
    s_waitcnt vmcnt(26)
    ds_read_b64_tr_b16 a[32:33], v232 offset:8192
    ds_read_b64_tr_b16 a[34:35], v232 offset:9216
    ds_read_b64_tr_b16 a[36:37], v233 offset:8192
    ds_read_b64_tr_b16 a[38:39], v233 offset:9216
    s_add_u32 s2, s76, 243712
    buffer_load_dwordx4 v167, s[60:63], s2 offen offset:2048 lds
    s_add_u32 s2, s76, 250880
    buffer_load_dwordx4 v167, s[60:63], s2 offen offset:3072 lds
    s_waitcnt vmcnt(26)
    ds_read_b64_tr_b16 a[40:41], v232 offset:10240
    ds_read_b64_tr_b16 a[42:43], v232 offset:11264
    ds_read_b64_tr_b16 a[44:45], v233 offset:10240
    ds_read_b64_tr_b16 a[46:47], v233 offset:11264
    s_waitcnt lgkmcnt(15)
    s_add_u32 m0, s78, 0
    s_add_u32 s2, s76, 262144
    buffer_load_dwordx4 v167, s[60:63], s2 offen offset:0 lds
    s_waitcnt vmcnt(6)
    s_barrier
    s_cmp_eq_u32 s5, 0
    s_cbranch_scc0 noflag_5
    s_lshl_b32 s86, s3, 4
    s_add_u32 s86, s86, s4
    s_lshl_b32 s86, s86, 7
    s_add_u32 s86, s86, 12845056
    v_mov_b32 v12, s90
    v_mov_b32 v13, s91
    s_mov_b64 s[42:43], exec
    s_mov_b64 exec, 1
    buffer_store_dwordx2 v[12:13], off, s[56:59], s86 sc1
    s_mov_b64 exec, s[42:43]
noflag_5:
    v_permlane16_swap_b32 v16, v32
    v_permlane16_swap_b32 v17, v33
    v_permlane16_swap_b32 v18, v34
    v_permlane16_swap_b32 v19, v35
    v_permlane16_swap_b32 v20, v36
    v_permlane16_swap_b32 v21, v37
    v_permlane16_swap_b32 v22, v38
    v_permlane16_swap_b32 v23, v39
    v_permlane16_swap_b32 v24, v40
    v_permlane16_swap_b32 v25, v41
    v_permlane16_swap_b32 v26, v42
    v_permlane16_swap_b32 v27, v43
    v_permlane16_swap_b32 v28, v44
    s_add_u32 s2, s76, 269312
    buffer_load_dwordx4 v167, s[60:63], s2 offen offset:1024 lds
    ds_read_b64_tr_b16 a[48:49], v232 offset:12288
    ds_read_b64_tr_b16 a[50:51], v232 offset:13312
    ds_read_b64_tr_b16 a[52:53], v233 offset:12288
    ds_read_b64_tr_b16 a[54:55], v233 offset:13312
    v_permlane16_swap_b32 v29, v45
    v_permlane16_swap_b32 v30, v46
    v_permlane16_swap_b32 v31, v47
    v_pk_mul_f32 v[196:197], v[32:33], v[176:177] op_sel:[0,1] op_sel_hi:[1,1]
    v_pk_mul_f32 v[198:199], v[16:17], v[176:177] op_sel:[0,1] op_sel_hi:[1,1]
    v_pk_fma_f32 v[16:17], v[16:17], v[176:177], v[196:197] op_sel:[0,0,0] op_sel_hi:[1,0,1] neg_lo:[0,0,1] neg_hi:[0,0,1]
    v_pk_fma_f32 v[32:33], v[32:33], v[176:177], v[198:199] op_sel:[0,0,0] op_sel_hi:[1,0,1]
    v_pk_mul_f32 v[200:201], v[34:35], v[176:177] op_sel:[0,1] op_sel_hi:[1,1]
    v_pk_mul_f32 v[202:203], v[18:19], v[176:177] op_sel:[0,1] op_sel_hi:[1,1]
    v_pk_fma_f32 v[18:19], v[18:19], v[176:177], v[200:201] op_sel:[0,0,0] op_sel_hi:[1,0,1] neg_lo:[0,0,1] neg_hi:[0,0,1]
    v_pk_fma_f32 v[34:35], v[34:35], v[176:177], v[202:203] op_sel:[0,0,0] op_sel_hi:[1,0,1]
    v_pk_mul_f32 v[196:197], v[36:37], v[176:177] op_sel:[0,1] op_sel_hi:[1,1]
    v_pk_mul_f32 v[198:199], v[20:21], v[176:177] op_sel:[0,1] op_sel_hi:[1,1]
    s_add_u32 s2, s76, 276480
    buffer_load_dwordx4 v167, s[60:63], s2 offen offset:2048 lds
    v_pk_fma_f32 v[20:21], v[20:21], v[176:177], v[196:197] op_sel:[0,0,0] op_sel_hi:[1,0,1] neg_lo:[0,0,1] neg_hi:[0,0,1]
    v_pk_fma_f32 v[36:37], v[36:37], v[176:177], v[198:199] op_sel:[0,0,0] op_sel_hi:[1,0,1]
    v_pk_mul_f32 v[200:201], v[38:39], v[176:177] op_sel:[0,1] op_sel_hi:[1,1]
    v_pk_mul_f32 v[202:203], v[22:23], v[176:177] op_sel:[0,1] op_sel_hi:[1,1]
    v_pk_fma_f32 v[22:23], v[22:23], v[176:177], v[200:201] op_sel:[0,0,0] op_sel_hi:[1,0,1] neg_lo:[0,0,1] neg_hi:[0,0,1]
    v_pk_fma_f32 v[38:39], v[38:39], v[176:177], v[202:203] op_sel:[0,0,0] op_sel_hi:[1,0,1]
    v_pk_mul_f32 v[196:197], v[40:41], v[176:177] op_sel:[0,1] op_sel_hi:[1,1]
    v_pk_mul_f32 v[198:199], v[24:25], v[176:177] op_sel:[0,1] op_sel_hi:[1,1]
    v_pk_fma_f32 v[24:25], v[24:25], v[176:177], v[196:197] op_sel:[0,0,0] op_sel_hi:[1,0,1] neg_lo:[0,0,1] neg_hi:[0,0,1]
    v_pk_fma_f32 v[40:41], v[40:41], v[176:177], v[198:199] op_sel:[0,0,0] op_sel_hi:[1,0,1]
    v_pk_mul_f32 v[200:201], v[42:43], v[176:177] op_sel:[0,1] op_sel_hi:[1,1]
    v_pk_mul_f32 v[202:203], v[26:27], v[176:177] op_sel:[0,1] op_sel_hi:[1,1]
    v_pk_fma_f32 v[26:27], v[26:27], v[176:177], v[200:201] op_sel:[0,0,0] op_sel_hi:[1,0,1] neg_lo:[0,0,1] neg_hi:[0,0,1]
    s_add_u32 s2, s76, 283648
    buffer_load_dwordx4 v167, s[60:63], s2 offen offset:3072 lds
    ds_read_b64_tr_b16 a[56:57], v232 offset:14336
    ds_read_b64_tr_b16 a[58:59], v232 offset:15360
    ds_read_b64_tr_b16 a[60:61], v233 offset:14336
    ds_read_b64_tr_b16 a[62:63], v233 offset:15360
    v_pk_fma_f32 v[42:43], v[42:43], v[176:177], v[202:203] op_sel:[0,0,0] op_sel_hi:[1,0,1]
    v_pk_mul_f32 v[196:197], v[44:45], v[176:177] op_sel:[0,1] op_sel_hi:[1,1]
    v_pk_mul_f32 v[198:199], v[28:29], v[176:177] op_sel:[0,1] op_sel_hi:[1,1]
    v_pk_fma_f32 v[28:29], v[28:29], v[176:177], v[196:197] op_sel:[0,0,0] op_sel_hi:[1,0,1] neg_lo:[0,0,1] neg_hi:[0,0,1]
    v_pk_fma_f32 v[44:45], v[44:45], v[176:177], v[198:199] op_sel:[0,0,0] op_sel_hi:[1,0,1]
    v_pk_mul_f32 v[200:201], v[46:47], v[176:177] op_sel:[0,1] op_sel_hi:[1,1]
    v_pk_mul_f32 v[202:203], v[30:31], v[176:177] op_sel:[0,1] op_sel_hi:[1,1]
    v_pk_fma_f32 v[30:31], v[30:31], v[176:177], v[200:201] op_sel:[0,0,0] op_sel_hi:[1,0,1] neg_lo:[0,0,1] neg_hi:[0,0,1]
    v_pk_fma_f32 v[46:47], v[46:47], v[176:177], v[202:203] op_sel:[0,0,0] op_sel_hi:[1,0,1]
    v_pk_fma_f32 v[196:197], v[32:33], v[168:169], v[18:19] op_sel:[0,1,0] op_sel_hi:[1,1,1] neg_lo:[0,1,0] neg_hi:[0,1,0]
    v_pk_fma_f32 v[198:199], v[16:17], v[168:169], v[34:35] op_sel:[0,1,0] op_sel_hi:[1,1,1]
    v_pk_fma_f32 v[204:205], v[16:17], v[168:169], v[196:197] op_sel:[0,0,0] op_sel_hi:[1,0,1]
    v_pk_fma_f32 v[206:207], v[32:33], v[168:169], v[198:199] op_sel:[0,0,0] op_sel_hi:[1,0,1]
    s_waitcnt lgkmcnt(15)
    s_add_u32 m0, s78, 4096
    s_add_u32 s2, s76, 294912
    buffer_load_dwordx4 v167, s[60:63], s2 offen offset:0 lds
    v_pk_fma_f32 v[196:197], v[206:207], v[168:169], v[20:21] op_sel:[0,1,0] op_sel_hi:[1,1,1] neg_lo:[0,1,0] neg_hi:[0,1,0]
    v_pk_fma_f32 v[198:199], v[204:205], v[168:169], v[36:37] op_sel:[0,1,0] op_sel_hi:[1,1,1]
    v_pk_fma_f32 v[204:205], v[204:205], v[168:169], v[196:197] op_sel:[0,0,0] op_sel_hi:[1,0,1]
    v_pk_fma_f32 v[206:207], v[206:207], v[168:169], v[198:199] op_sel:[0,0,0] op_sel_hi:[1,0,1]
    v_pk_fma_f32 v[196:197], v[206:207], v[168:169], v[22:23] op_sel:[0,1,0] op_sel_hi:[1,1,1] neg_lo:[0,1,0] neg_hi:[0,1,0]
    v_pk_fma_f32 v[198:199], v[204:205], v[168:169], v[38:39] op_sel:[0,1,0] op_sel_hi:[1,1,1]
    v_pk_fma_f32 v[204:205], v[204:205], v[168:169], v[196:197] op_sel:[0,0,0] op_sel_hi:[1,0,1]
    v_pk_fma_f32 v[206:207], v[206:207], v[168:169], v[198:199] op_sel:[0,0,0] op_sel_hi:[1,0,1]
    v_pk_fma_f32 v[196:197], v[206:207], v[168:169], v[24:25] op_sel:[0,1,0] op_sel_hi:[1,1,1] neg_lo:[0,1,0] neg_hi:[0,1,0]
    v_pk_fma_f32 v[198:199], v[204:205], v[168:169], v[40:41] op_sel:[0,1,0] op_sel_hi:[1,1,1]
    v_pk_fma_f32 v[204:205], v[204:205], v[168:169], v[196:197] op_sel:[0,0,0] op_sel_hi:[1,0,1]
    v_pk_fma_f32 v[206:207], v[206:207], v[168:169], v[198:199] op_sel:[0,0,0] op_sel_hi:[1,0,1]
    v_pk_fma_f32 v[196:197], v[206:207], v[168:169], v[26:27] op_sel:[0,1,0] op_sel_hi:[1,1,1] neg_lo:[0,1,0] neg_hi:[0,1,0]
    s_add_u32 s2, s76, 302080
    buffer_load_dwordx4 v167, s[60:63], s2 offen offset:1024 lds
    ds_read_b64_tr_b16 a[64:65], v232 offset:16384
    ds_read_b64_tr_b16 a[66:67], v232 offset:17408
    ds_read_b64_tr_b16 a[68:69], v233 offset:16384
    ds_read_b64_tr_b16 a[70:71], v233 offset:17408
    v_pk_fma_f32 v[198:199], v[204:205], v[168:169], v[42:43] op_sel:[0,1,0] op_sel_hi:[1,1,1]
    v_pk_fma_f32 v[204:205], v[204:205], v[168:169], v[196:197] op_sel:[0,0,0] op_sel_hi:[1,0,1]
    v_pk_fma_f32 v[206:207], v[206:207], v[168:169], v[198:199] op_sel:[0,0,0] op_sel_hi:[1,0,1]
    v_pk_fma_f32 v[196:197], v[206:207], v[168:169], v[28:29] op_sel:[0,1,0] op_sel_hi:[1,1,1] neg_lo:[0,1,0] neg_hi:[0,1,0]
    v_pk_fma_f32 v[198:199], v[204:205], v[168:169], v[44:45] op_sel:[0,1,0] op_sel_hi:[1,1,1]
    v_pk_fma_f32 v[204:205], v[204:205], v[168:169], v[196:197] op_sel:[0,0,0] op_sel_hi:[1,0,1]
    v_pk_fma_f32 v[206:207], v[206:207], v[168:169], v[198:199] op_sel:[0,0,0] op_sel_hi:[1,0,1]
    v_pk_fma_f32 v[196:197], v[206:207], v[168:169], v[30:31] op_sel:[0,1,0] op_sel_hi:[1,1,1] neg_lo:[0,1,0] neg_hi:[0,1,0]
    v_pk_fma_f32 v[198:199], v[204:205], v[168:169], v[46:47] op_sel:[0,1,0] op_sel_hi:[1,1,1]
    v_pk_fma_f32 v[204:205], v[204:205], v[168:169], v[196:197] op_sel:[0,0,0] op_sel_hi:[1,0,1]
    v_pk_fma_f32 v[206:207], v[206:207], v[168:169], v[198:199] op_sel:[0,0,0] op_sel_hi:[1,0,1]
    v_mov_b32 v194, v204
    v_mov_b32 v195, v206
    s_add_u32 s2, s76, 309248
    buffer_load_dwordx4 v167, s[60:63], s2 offen offset:2048 lds
    v_fma_f32 v196, -v171, v206, v205
    v_fma_f32 v197, v171, v204, v207
    v_fma_f32 v208, v170, v204, v196
    v_fma_f32 v209, v170, v206, v197
    ds_write_b64 v243, v[208:209]
    s_waitcnt lgkmcnt(0)
    s_barrier
    ds_read_b64 v[178:179], v244 offset:0
    ds_read_b64 v[180:181], v244 offset:128
    ds_read_b64 v[182:183], v244 offset:256
    ds_read_b64 v[184:185], v244 offset:384
    ds_read_b64 v[186:187], v244 offset:512
    ds_read_b64 v[188:189], v244 offset:640
    ds_read_b64 v[190:191], v244 offset:768
    ds_read_b64 v[192:193], v244 offset:896
    s_add_u32 s2, s76, 316416
    buffer_load_dwordx4 v167, s[60:63], s2 offen offset:3072 lds
    ds_read_b64_tr_b16 a[72:73], v232 offset:18432
    ds_read_b64_tr_b16 a[74:75], v232 offset:19456
    ds_read_b64_tr_b16 a[76:77], v233 offset:18432
    ds_read_b64_tr_b16 a[78:79], v233 offset:19456
    v_lshrrev_b32 v2, 4, v1
    s_lshl_b32 s86, s6, 2
    v_add_u32 v2, s86, v2
    v_cmp_eq_u32 vcc, 1, v2
    v_mov_b32 v228, 0
    v_mov_b32 v229, 0
    s_waitcnt lgkmcnt(11)
    v_cndmask_b32 v228, v228, v178, vcc
    v_cndmask_b32 v229, v229, v179, vcc
    v_cmp_eq_u32 vcc, 2, v2
    s_waitcnt lgkmcnt(10)
    v_fma_f32 v196, -v173, v179, v180
    v_fma_f32 v197, v173, v178, v181
    v_fma_f32 v204, v172, v178, v196
    v_fma_f32 v205, v172, v179, v197
    s_add_u32 m0, s78, 8192
    s_add_u32 s2, s76, 327680
    buffer_load_dwordx4 v167, s[60:63], s2 offen offset:0 lds
    v_cndmask_b32 v228, v228, v204, vcc
    v_cndmask_b32 v229, v229, v205, vcc
    v_cmp_eq_u32 vcc, 3, v2
    s_waitcnt lgkmcnt(9)
    v_fma_f32 v196, -v173, v205, v182
    v_fma_f32 v197, v173, v204, v183
    v_fma_f32 v204, v172, v204, v196
    v_fma_f32 v205, v172, v205, v197
    v_cndmask_b32 v228, v228, v204, vcc
    v_cndmask_b32 v229, v229, v205, vcc
    v_cmp_eq_u32 vcc, 4, v2
    s_waitcnt lgkmcnt(8)
    v_fma_f32 v196, -v173, v205, v184
    v_fma_f32 v197, v173, v204, v185
    v_fma_f32 v204, v172, v204, v196
    s_add_u32 s2, s76, 334848
    buffer_load_dwordx4 v167, s[60:63], s2 offen offset:1024 lds
    ds_read_b64_tr_b16 a[80:81], v232 offset:20480
    ds_read_b64_tr_b16 a[82:83], v232 offset:21504
    ds_read_b64_tr_b16 a[84:85], v233 offset:20480
    ds_read_b64_tr_b16 a[86:87], v233 offset:21504
    v_fma_f32 v205, v172, v205, v197
    v_cndmask_b32 v228, v228, v204, vcc
    v_cndmask_b32 v229, v229, v205, vcc
    v_cmp_eq_u32 vcc, 5, v2
    s_waitcnt lgkmcnt(11)
    v_fma_f32 v196, -v173, v205, v186
    v_fma_f32 v197, v173, v204, v187
    v_fma_f32 v204, v172, v204, v196
    v_fma_f32 v205, v172, v205, v197
    v_cndmask_b32 v228, v228, v204, vcc
    v_cndmask_b32 v229, v229, v205, vcc
    v_cmp_eq_u32 vcc, 6, v2
    s_waitcnt lgkmcnt(10)
    v_fma_f32 v196, -v173, v205, v188
    v_fma_f32 v197, v173, v204, v189
    s_add_u32 s2, s76, 342016
    buffer_load_dwordx4 v167, s[60:63], s2 offen offset:2048 lds
    v_fma_f32 v204, v172, v204, v196
    v_fma_f32 v205, v172, v205, v197
    v_cndmask_b32 v228, v228, v204, vcc
    v_cndmask_b32 v229, v229, v205, vcc
    v_cmp_eq_u32 vcc, 7, v2
    s_waitcnt lgkmcnt(9)
    v_fma_f32 v196, -v173, v205, v190
    v_fma_f32 v197, v173, v204, v191
    v_fma_f32 v204, v172, v204, v196
    v_fma_f32 v205, v172, v205, v197
    v_cndmask_b32 v228, v228, v204, vcc
    v_cndmask_b32 v229, v229, v205, vcc
    s_waitcnt lgkmcnt(8)
    v_fma_f32 v196, -v173, v205, v192
    v_fma_f32 v197, v173, v204, v193
    s_add_u32 s2, s76, 349184
    buffer_load_dwordx4 v167, s[60:63], s2 offen offset:3072 lds
    ds_read_b64_tr_b16 a[88:89], v232 offset:22528
    ds_read_b64_tr_b16 a[90:91], v232 offset:23552
    ds_read_b64_tr_b16 a[92:93], v233 offset:22528
    ds_read_b64_tr_b16 a[94:95], v233 offset:23552
    v_fma_f32 v204, v172, v204, v196
    v_fma_f32 v205, v172, v205, v197
    s_cmp_eq_u32 s6, 0
    s_cbranch_scc0 nos_6
    v_mov_b32 v208, v204
    v_mov_b32 v209, s90
    v_mov_b32 v210, v205
    v_mov_b32 v211, s90
    s_lshl_b32 s86, s3, 4
    s_add_u32 s86, s86, s4
    s_lshl_b32 s86, s86, 1
    s_add_u32 s86, s86, s7
    s_lshl_b32 s86, s86, 8
    s_add_u32 s86, s86, 12648448
    v_lshlrev_b32 v4, 4, v1
    v_add_u32 v4, s86, v4
    s_mov_b64 s[42:43], exec
    s_mov_b64 exec, 0xffff
    buffer_store_dwordx4 v[208:211], v4, s[56:59], 0 offen sc1
    s_mov_b64 exec, s[42:43]
nos_6:
    v_mov_b32 v9, s90
    v_mov_b32 v8, 0x40000000
    v_cmp_gt_u32 vcc, v8, v245
    s_nop 1
    v_cndmask_b32 v216, 0, v9, vcc
    v_cmp_gt_u32 vcc, v8, v246
    s_nop 1
    v_cndmask_b32 v217, 0, v9, vcc
    v_cmp_gt_u32 vcc, v8, v247
    s_nop 1
    v_cndmask_b32 v218, 0, v9, vcc
    v_cmp_gt_u32 vcc, v8, v248
    s_nop 1
    v_cndmask_b32 v219, 0, v9, vcc
    s_mov_b32 s86, 12845056
    buffer_load_dwordx2 v[162:163], v239, s[56:59], s86 offen sc1
    s_add_u32 m0, s78, 12288
    s_add_u32 s2, s76, 360448
    buffer_load_dwordx4 v167, s[60:63], s2 offen offset:0 lds
    s_add_u32 s2, s76, 367616
    buffer_load_dwordx4 v167, s[60:63], s2 offen offset:1024 lds
    ds_read_b64_tr_b16 a[96:97], v232 offset:24576
    ds_read_b64_tr_b16 a[98:99], v232 offset:25600
    ds_read_b64_tr_b16 a[100:101], v233 offset:24576
    ds_read_b64_tr_b16 a[102:103], v233 offset:25600
    s_add_u32 s2, s76, 374784
    buffer_load_dwordx4 v167, s[60:63], s2 offen offset:2048 lds
    s_add_u32 s2, s76, 381952
    buffer_load_dwordx4 v167, s[60:63], s2 offen offset:3072 lds
    s_waitcnt vmcnt(21)
    ds_read_b64_tr_b16 a[104:105], v232 offset:26624
    ds_read_b64_tr_b16 a[106:107], v232 offset:27648
    ds_read_b64_tr_b16 a[108:109], v233 offset:26624
    ds_read_b64_tr_b16 a[110:111], v233 offset:27648
    s_add_u32 m0, s78, 16384
    s_add_u32 s2, s76, 393216
    buffer_load_dwordx4 v167, s[60:63], s2 offen offset:0 lds
    s_add_u32 s2, s76, 400384
    buffer_load_dwordx4 v167, s[60:63], s2 offen offset:1024 lds
    s_waitcnt vmcnt(21)
    ds_read_b64_tr_b16 a[112:113], v232 offset:28672
    ds_read_b64_tr_b16 a[114:115], v232 offset:29696
    ds_read_b64_tr_b16 a[116:117], v233 offset:28672
    ds_read_b64_tr_b16 a[118:119], v233 offset:29696
    s_waitcnt vmcnt(6)
    v_xor_b32 v162, s90, v162
    v_xor_b32 v163, s91, v163
    v_or_b32 v162, v162, v163
    v_cmp_ne_u32 vcc, 0, v162
    s_nop 0
    s_cbranch_vccz poll_ok_8
    s_mov_b32 s100, 0
    s_mov_b32 s86, 12845056
poll_7:
    buffer_load_dwordx2 v[162:163], v239, s[56:59], s86 offen sc1
    s_waitcnt vmcnt(0)
    v_xor_b32 v162, s90, v162
    v_xor_b32 v163, s91, v163
    v_or_b32 v162, v162, v163
    v_cmp_ne_u32 vcc, 0, v162
    s_add_u32 s100, s100, 1
    s_cmp_gt_u32 s100, 100000
    s_cbranch_scc1 poll_ok_8
    s_cbranch_vccnz poll_7
poll_ok_8:
    s_add_u32 s0, s30, 0
    buffer_load_dwordx4 v[112:115], v238, s[56:59], s0 offen offset:0 sc1
    buffer_load_dwordx4 v[116:119], v238, s[56:59], s0 offen offset:1024 sc1
    buffer_load_dwordx4 v[120:123], v238, s[56:59], s0 offen offset:2048 sc1
    buffer_load_dwordx4 v[124:127], v238, s[56:59], s0 offen offset:3072 sc1
    s_add_u32 s0, s30, 4096
    buffer_load_dwordx4 v[128:131], v238, s[56:59], s0 offen offset:0 sc1
    buffer_load_dwordx4 v[132:135], v238, s[56:59], s0 offen offset:1024 sc1
    buffer_load_dwordx4 v[136:139], v238, s[56:59], s0 offen offset:2048 sc1
    buffer_load_dwordx4 v[140:143], v238, s[56:59], s0 offen offset:3072 sc1
    s_add_u32 s0, s30, 8192
    buffer_load_dwordx4 v[144:147], v238, s[56:59], s0 offen offset:0 sc1
    buffer_load_dwordx4 v[148:151], v238, s[56:59], s0 offen offset:1024 sc1
    buffer_load_dwordx4 a[224:227], v238, s[56:59], s0 offen offset:2048 sc1
    buffer_load_dwordx4 a[228:231], v238, s[56:59], s0 offen offset:3072 sc1
    buffer_load_dword v160, v240, s[56:59], 0 offen sc1
    buffer_load_dword v161, v240, s[56:59], 0 offen offset:64 sc1
    buffer_load_dwordx4 v[196:199], v245, s[56:59], 0 offen sc1
    buffer_load_dwordx4 v[200:203], v246, s[56:59], 0 offen sc1
    buffer_load_dwordx4 v[204:207], v247, s[56:59], 0 offen sc1
    buffer_load_dwordx4 v[208:211], v248, s[56:59], 0 offen sc1
    s_waitcnt vmcnt(16)
    v_mfma_f32_32x32x16_bf16 v[48:63], a[0:3], v[112:115], 0
    s_waitcnt lgkmcnt(15)
    s_add_u32 s2, s76, 407552
    buffer_load_dwordx4 v167, s[60:63], s2 offen offset:2048 lds
    v_mfma_f32_32x32x16_bf16 v[64:79], a[0:3], v[116:119], 0
    s_add_u32 s2, s76, 414720
    buffer_load_dwordx4 v167, s[60:63], s2 offen offset:3072 lds
    ds_read_b64_tr_b16 a[120:121], v232 offset:30720
    ds_read_b64_tr_b16 a[122:123], v232 offset:31744
    ds_read_b64_tr_b16 a[124:125], v233 offset:30720
    ds_read_b64_tr_b16 a[126:127], v233 offset:31744
    v_mfma_f32_32x32x16_bf16 v[80:95], a[4:7], v[112:115], 0
    v_mfma_f32_32x32x16_bf16 v[96:111], a[4:7], v[116:119], 0
    s_add_u32 s0, s30, 12288
    buffer_load_dwordx4 a[232:235], v238, s[56:59], s0 offen offset:0 sc1
    buffer_load_dwordx4 a[236:239], v238, s[56:59], s0 offen offset:1024 sc1
    buffer_load_dwordx4 a[240:243], v238, s[56:59], s0 offen offset:2048 sc1
    buffer_load_dwordx4 a[244:247], v238, s[56:59], s0 offen offset:3072 sc1
    s_waitcnt vmcnt(6)
    v_mov_b32 v7, 0
    v_bitop3_b32 v7, v7, v216, v197 bitop3:0xf6
    v_bitop3_b32 v7, v7, v216, v199 bitop3:0xf6
    v_bitop3_b32 v7, v7, v217, v201 bitop3:0xf6
    v_bitop3_b32 v7, v7, v217, v203 bitop3:0xf6
    v_bitop3_b32 v7, v7, v218, v205 bitop3:0xf6
    v_bitop3_b32 v7, v7, v218, v207 bitop3:0xf6
    v_bitop3_b32 v7, v7, v219, v209 bitop3:0xf6
    v_bitop3_b32 v7, v7, v219, v211 bitop3:0xf6
    v_cmp_ne_u32 vcc, 0, v7
    s_nop 0
    s_cbranch_vccz lb_ok_10
    s_mov_b32 s100, 0
lb_9:
    buffer_load_dwordx4 v[196:199], v245, s[56:59], 0 offen sc1
    buffer_load_dwordx4 v[200:203], v246, s[56:59], 0 offen sc1
    buffer_load_dwordx4 v[204:207], v247, s[56:59], 0 offen sc1
    buffer_load_dwordx4 v[208:211], v248, s[56:59], 0 offen sc1
    s_waitcnt vmcnt(0)
    v_mov_b32 v7, 0
    v_bitop3_b32 v7, v7, v216, v197 bitop3:0xf6
    v_bitop3_b32 v7, v7, v216, v199 bitop3:0xf6
    v_bitop3_b32 v7, v7, v217, v201 bitop3:0xf6
    v_bitop3_b32 v7, v7, v217, v203 bitop3:0xf6
    v_bitop3_b32 v7, v7, v218, v205 bitop3:0xf6
    v_bitop3_b32 v7, v7, v218, v207 bitop3:0xf6
    v_bitop3_b32 v7, v7, v219, v209 bitop3:0xf6
    v_bitop3_b32 v7, v7, v219, v211 bitop3:0xf6
    v_cmp_ne_u32 vcc, 0, v7
    s_add_u32 s100, s100, 1
    s_cmp_gt_u32 s100, 100000
    s_cbranch_scc1 lb_ok_10
    s_cbranch_vccnz lb_9
lb_ok_10:
    v_mfma_f32_32x32x16_bf16 v[48:63], a[8:11], v[120:123], v[48:63]
    s_add_u32 m0, s78, 20480
    s_add_u32 s2, s76, 425984
    buffer_load_dwordx4 v167, s[60:63], s2 offen offset:0 lds
    v_fma_f32 v10, -v175, v210, v204
    v_fma_f32 v11, v175, v208, v206
    v_fma_f32 v8, v174, v208, v10
    v_fma_f32 v9, v174, v210, v11
    v_fma_f32 v10, -v175, v9, v200
    v_fma_f32 v11, v175, v8, v202
    v_mfma_f32_32x32x16_bf16 v[64:79], a[8:11], v[124:127], v[64:79]
    s_add_u32 s2, s76, 433152
    buffer_load_dwordx4 v167, s[60:63], s2 offen offset:1024 lds
    ds_read_b64_tr_b16 a[128:129], v232 offset:0
    ds_read_b64_tr_b16 a[130:131], v232 offset:1024
    ds_read_b64_tr_b16 a[132:133], v233 offset:0
    ds_read_b64_tr_b16 a[134:135], v233 offset:1024
    v_fma_f32 v8, v174, v8, v10
    v_fma_f32 v9, v174, v9, v11
    v_fma_f32 v10, -v175, v9, v196
    v_fma_f32 v11, v175, v8, v198
    v_fma_f32 v8, v174, v8, v10
    v_fma_f32 v9, v174, v9, v11
    v_mfma_f32_32x32x16_bf16 v[80:95], a[12:15], v[120:123], v[80:95]
    v_mul_f32 v10, v251, v9
    v_mul_f32 v11, v251, v8
    v_fma_f32 v8, v250, v8, -v10
    v_fma_f32 v9, v250, v9, v11
    v_mov_b32 v10, v8
    v_mov_b32 v11, v9
    v_mfma_f32_32x32x16_bf16 v[96:111], a[12:15], v[124:127], v[96:111]
    v_permlane16_swap_b32 v8, v10
    v_permlane16_swap_b32 v9, v11
    v_add_f32 v8, v8, v10
    v_add_f32 v9, v9, v11
    v_mov_b32 v10, v8
    v_mov_b32 v11, v9
    s_add_u32 s0, s30, 16384
    buffer_load_dwordx4 a[248:251], v238, s[56:59], s0 offen offset:0 sc1
    buffer_load_dwordx4 a[252:255], v238, s[56:59], s0 offen offset:1024 sc1
    buffer_load_dwordx4 v[112:115], v238, s[56:59], s0 offen offset:2048 sc1
    buffer_load_dwordx4 v[116:119], v238, s[56:59], s0 offen offset:3072 sc1
    v_mfma_f32_32x32x16_bf16 v[48:63], a[16:19], v[128:131], v[48:63]
    s_waitcnt lgkmcnt(15)
    s_add_u32 s2, s76, 440320
    buffer_load_dwordx4 v167, s[60:63], s2 offen offset:2048 lds
    v_permlane32_swap_b32 v8, v10
    v_permlane32_swap_b32 v9, v11
    v_add_f32 v8, v8, v10
    v_add_f32 v9, v9, v11
    v_fma_f32 v10, -v231, v9, v228
    v_fma_f32 v11, v231, v8, v229
    v_mfma_f32_32x32x16_bf16 v[64:79], a[16:19], v[132:135], v[64:79]
    s_add_u32 s2, s76, 447488
    buffer_load_dwordx4 v167, s[60:63], s2 offen offset:3072 lds
    ds_read_b64_tr_b16 a[136:137], v232 offset:2048
    ds_read_b64_tr_b16 a[138:139], v232 offset:3072
    ds_read_b64_tr_b16 a[140:141], v233 offset:2048
    ds_read_b64_tr_b16 a[142:143], v233 offset:3072
    v_fma_f32 v8, v230, v8, v10
    v_fma_f32 v9, v230, v9, v11
    v_mov_b32 v212, v8
    v_mov_b32 v214, v9
    v_fma_f32 v10, -v171, v9, v194
    v_fma_f32 v11, v171, v8, v195
    v_mfma_f32_32x32x16_bf16 v[80:95], a[20:23], v[128:131], v[80:95]
    v_fma_f32 v213, v170, v8, v10
    v_fma_f32 v215, v170, v9, v11
    v_fma_f32 v216, -v169, v214, v16
    v_fma_f32 v218, v169, v212, v32
    v_fma_f32 v217, -v169, v215, v17
    v_fma_f32 v219, v169, v213, v33
    v_mfma_f32_32x32x16_bf16 v[96:111], a[20:23], v[132:135], v[96:111]
    v_fma_f32 v16, v168, v212, v216
    v_fma_f32 v32, v168, v214, v218
    v_fma_f32 v17, v168, v213, v217
    v_fma_f32 v33, v168, v215, v219
    v_fma_f32 v216, -v169, v32, v18
    v_fma_f32 v218, v169, v16, v34
    s_add_u32 s0, s30, 20480
    buffer_load_dwordx4 v[120:123], v238, s[56:59], s0 offen offset:0 sc1
    buffer_load_dwordx4 v[124:127], v238, s[56:59], s0 offen offset:1024 sc1
    v_mfma_f32_32x32x16_bf16 v[48:63], a[24:27], v[136:139], v[48:63]
    s_add_u32 m0, s78, 24576
    s_add_u32 s2, s77, 0
    buffer_load_dwordx4 v164, s[64:67], s2 offen offset:0 lds
    v_fma_f32 v217, -v169, v33, v19
    v_fma_f32 v219, v169, v17, v35
    v_fma_f32 v18, v168, v16, v216
    v_fma_f32 v34, v168, v32, v218
    v_fma_f32 v19, v168, v17, v217
    v_fma_f32 v35, v168, v33, v219
    v_mfma_f32_32x32x16_bf16 v[64:79], a[24:27], v[140:143], v[64:79]
    s_add_u32 s2, s77, 7168
    buffer_load_dwordx4 v165, s[64:67], s2 offen offset:1024 lds
    ds_read_b64_tr_b16 a[144:145], v232 offset:4096
    ds_read_b64_tr_b16 a[146:147], v232 offset:5120
    ds_read_b64_tr_b16 a[148:149], v233 offset:4096
    ds_read_b64_tr_b16 a[150:151], v233 offset:5120
    v_fma_f32 v216, -v169, v34, v20
    v_fma_f32 v218, v169, v18, v36
    v_fma_f32 v217, -v169, v35, v21
    v_fma_f32 v219, v169, v19, v37
    v_fma_f32 v20, v168, v18, v216
    v_fma_f32 v36, v168, v34, v218
    v_mfma_f32_32x32x16_bf16 v[80:95], a[28:31], v[136:139], v[80:95]
    v_fma_f32 v21, v168, v19, v217
    v_fma_f32 v37, v168, v35, v219
    v_fma_f32 v216, -v169, v36, v22
    v_fma_f32 v218, v169, v20, v38
    v_fma_f32 v217, -v169, v37, v23
    v_fma_f32 v219, v169, v21, v39
    v_mfma_f32_32x32x16_bf16 v[96:111], a[28:31], v[140:143], v[96:111]
    v_fma_f32 v22, v168, v20, v216
    v_fma_f32 v38, v168, v36, v218
    v_fma_f32 v23, v168, v21, v217
    v_fma_f32 v39, v168, v37, v219
    v_fma_f32 v216, -v169, v38, v24
    v_fma_f32 v218, v169, v22, v40
    buffer_load_dwordx4 v[128:131], v238, s[56:59], s0 offen offset:2048 sc1
    buffer_load_dwordx4 v[132:135], v238, s[56:59], s0 offen offset:3072 sc1
    v_mfma_f32_32x32x16_bf16 v[48:63], a[32:35], v[144:147], v[48:63]
    s_waitcnt lgkmcnt(15)
    s_add_u32 s2, s77, 14336
    buffer_load_dwordx4 v164, s[64:67], s2 offen offset:2048 lds
    v_fma_f32 v217, -v169, v39, v25
    v_fma_f32 v219, v169, v23, v41
    v_fma_f32 v24, v168, v22, v216
    v_fma_f32 v40, v168, v38, v218
    v_fma_f32 v25, v168, v23, v217
    v_fma_f32 v41, v168, v39, v219
    v_mfma_f32_32x32x16_bf16 v[64:79], a[32:35], v[148:151], v[64:79]
    s_add_u32 s2, s77, 21504
    buffer_load_dwordx4 v165, s[64:67], s2 offen offset:3072 lds
    ds_read_b64_tr_b16 a[152:153], v232 offset:6144
    ds_read_b64_tr_b16 a[154:155], v232 offset:7168
    ds_read_b64_tr_b16 a[156:157], v233 offset:6144
    ds_read_b64_tr_b16 a[158:159], v233 offset:7168
    v_fma_f32 v216, -v169, v40, v26
    v_fma_f32 v218, v169, v24, v42
    v_fma_f32 v217, -v169, v41, v27
    v_fma_f32 v219, v169, v25, v43
    v_fma_f32 v26, v168, v24, v216
    v_fma_f32 v42, v168, v40, v218
    v_mfma_f32_32x32x16_bf16 v[80:95], a[36:39], v[144:147], v[80:95]
    v_fma_f32 v27, v168, v25, v217
    v_fma_f32 v43, v168, v41, v219
    v_fma_f32 v216, -v169, v42, v28
    v_fma_f32 v218, v169, v26, v44
    v_fma_f32 v217, -v169, v43, v29
    v_fma_f32 v219, v169, v27, v45
    v_mfma_f32_32x32x16_bf16 v[96:111], a[36:39], v[148:151], v[96:111]
    v_fma_f32 v28, v168, v26, v216
    v_fma_f32 v44, v168, v42, v218
    v_fma_f32 v29, v168, v27, v217
    v_fma_f32 v45, v168, v43, v219
    v_fma_f32 v216, -v169, v44, v30
    v_fma_f32 v218, v169, v28, v46
    s_add_u32 s0, s30, 24576
    buffer_load_dwordx4 v[136:139], v238, s[56:59], s0 offen offset:0 sc1
    buffer_load_dwordx4 v[140:143], v238, s[56:59], s0 offen offset:1024 sc1
    v_mfma_f32_32x32x16_bf16 v[48:63], a[40:43], a[224:227], v[48:63]
    s_add_u32 m0, s78, 28672
    s_add_u32 s2, s77, 32768
    buffer_load_dwordx4 v164, s[64:67], s2 offen offset:0 lds
    v_fma_f32 v217, -v169, v45, v31
    v_fma_f32 v219, v169, v29, v47
    v_fma_f32 v30, v168, v28, v216
    v_fma_f32 v46, v168, v44, v218
    v_fma_f32 v31, v168, v29, v217
    v_fma_f32 v47, v168, v45, v219
    v_mfma_f32_32x32x16_bf16 v[64:79], a[40:43], a[228:231], v[64:79]
    s_add_u32 s2, s77, 39936
    buffer_load_dwordx4 v165, s[64:67], s2 offen offset:1024 lds
    ds_read_b64_tr_b16 a[160:161], v232 offset:8192
    ds_read_b64_tr_b16 a[162:163], v232 offset:9216
    ds_read_b64_tr_b16 a[164:165], v233 offset:8192
    ds_read_b64_tr_b16 a[166:167], v233 offset:9216
    v_cvt_pk_bf16_f32 v196, v16, -v32
    ds_write_b32 v252, v196 offset:0
    v_cvt_pk_bf16_f32 v197, v17, -v33
    ds_write_b32 v252, v197 offset:64
    v_cvt_pk_bf16_f32 v198, v18, -v34
    ds_write_b32 v252, v198 offset:128
    v_mfma_f32_32x32x16_bf16 v[80:95], a[44:47], a[224:227], v[80:95]
    v_cvt_pk_bf16_f32 v199, v19, -v35
    ds_write_b32 v252, v199 offset:192
    v_cvt_pk_bf16_f32 v200, v20, -v36
    ds_write_b32 v253, v200 offset:512
    v_cvt_pk_bf16_f32 v201, v21, -v37
    ds_write_b32 v253, v201 offset:576
    v_mfma_f32_32x32x16_bf16 v[96:111], a[44:47], a[228:231], v[96:111]
    v_cvt_pk_bf16_f32 v202, v22, -v38
    ds_write_b32 v253, v202 offset:640
    v_cvt_pk_bf16_f32 v203, v23, -v39
    ds_write_b32 v253, v203 offset:704
    v_cvt_pk_bf16_f32 v204, v24, -v40
    ds_write_b32 v252, v204 offset:1024
    buffer_load_dwordx4 v[144:147], v238, s[56:59], s0 offen offset:2048 sc1
    buffer_load_dwordx4 v[148:151], v238, s[56:59], s0 offen offset:3072 sc1
    s_waitcnt vmcnt(24)
    v_mfma_f32_32x32x16_bf16 v[48:63], a[48:51], a[232:235], v[48:63]
    s_waitcnt lgkmcnt(15)
    s_add_u32 s2, s77, 47104
    buffer_load_dwordx4 v164, s[64:67], s2 offen offset:2048 lds
    v_cvt_pk_bf16_f32 v205, v25, -v41
    ds_write_b32 v252, v205 offset:1088
    v_cvt_pk_bf16_f32 v206, v26, -v42
    ds_write_b32 v252, v206 offset:1152
    v_cvt_pk_bf16_f32 v207, v27, -v43
    v_mfma_f32_32x32x16_bf16 v[64:79], a[48:51], a[236:239], v[64:79]
    s_add_u32 s2, s77, 54272
    buffer_load_dwordx4 v165, s[64:67], s2 offen offset:3072 lds
    ds_read_b64_tr_b16 a[168:169], v232 offset:10240
    ds_read_b64_tr_b16 a[170:171], v232 offset:11264
    ds_read_b64_tr_b16 a[172:173], v233 offset:10240
    ds_read_b64_tr_b16 a[174:175], v233 offset:11264
    ds_write_b32 v252, v207 offset:1216
    v_cvt_pk_bf16_f32 v208, v28, -v44
    ds_write_b32 v253, v208 offset:1536
    v_cvt_pk_bf16_f32 v209, v29, -v45
    ds_write_b32 v253, v209 offset:1600
    v_cvt_pk_bf16_f32 v210, v30, -v46
    v_mfma_f32_32x32x16_bf16 v[80:95], a[52:55], a[232:235], v[80:95]
    ds_write_b32 v253, v210 offset:1664
    v_cvt_pk_bf16_f32 v211, v31, -v47
    ds_write_b32 v253, v211 offset:1728
    s_waitcnt lgkmcnt(0)
    ds_read_b128 v[212:215], v254 offset:0
    ds_read_b128 v[216:219], v254 offset:2048
    v_mfma_f32_32x32x16_bf16 v[96:111], a[52:55], a[236:239], v[96:111]
    ds_read_b128 v[220:223], v255 offset:0
    ds_read_b128 v[224:227], v255 offset:2048
    s_waitcnt lgkmcnt(3)
    buffer_store_dwordx4 v[212:215], v249, s[56:59], 0 offen offset:0 sc1
    s_waitcnt lgkmcnt(2)
    buffer_store_dwordx4 v[216:219], v249, s[56:59], 0 offen offset:1024 sc1
    s_waitcnt lgkmcnt(1)
    buffer_store_dwordx4 v[220:223], v249, s[56:59], 0 offen offset:2048 sc1
    s_waitcnt lgkmcnt(0)
    buffer_store_dwordx4 v[224:227], v249, s[56:59], 0 offen offset:3072 sc1
    s_add_u32 s0, s30, 28672
    buffer_load_dwordx4 a[224:227], v238, s[56:59], s0 offen offset:0 sc1
    buffer_load_dwordx4 a[228:231], v238, s[56:59], s0 offen offset:1024 sc1
    s_waitcnt vmcnt(30)
    v_mfma_f32_32x32x16_bf16 v[48:63], a[56:59], a[240:243], v[48:63]
    s_add_u32 m0, s78, 0
    s_add_u32 s2, s77, 0
    buffer_load_dwordx4 v164, s[68:71], s2 offen offset:0 lds
    v_mfma_f32_32x32x16_bf16 v[64:79], a[56:59], a[244:247], v[64:79]
    s_add_u32 s2, s77, 7168
    buffer_load_dwordx4 v165, s[68:71], s2 offen offset:1024 lds
    ds_read_b64_tr_b16 a[176:177], v232 offset:12288
    ds_read_b64_tr_b16 a[178:179], v232 offset:13312
    ds_read_b64_tr_b16 a[180:181], v233 offset:12288
    ds_read_b64_tr_b16 a[182:183], v233 offset:13312
    v_mfma_f32_32x32x16_bf16 v[80:95], a[60:63], a[240:243], v[80:95]
    v_mfma_f32_32x32x16_bf16 v[96:111], a[60:63], a[244:247], v[96:111]
    buffer_load_dwordx4 a[232:235], v238, s[56:59], s0 offen offset:2048 sc1
    buffer_load_dwordx4 a[236:239], v238, s[56:59], s0 offen offset:3072 sc1
    s_waitcnt vmcnt(30)
    v_mfma_f32_32x32x16_bf16 v[48:63], a[64:67], a[248:251], v[48:63]
    s_add_u32 s2, s77, 14336
    buffer_load_dwordx4 v164, s[68:71], s2 offen offset:2048 lds
    v_mfma_f32_32x32x16_bf16 v[64:79], a[64:67], a[252:255], v[64:79]
    s_add_u32 s2, s77, 21504
    buffer_load_dwordx4 v165, s[68:71], s2 offen offset:3072 lds
    ds_read_b64_tr_b16 a[184:185], v232 offset:14336
    ds_read_b64_tr_b16 a[186:187], v232 offset:15360
    ds_read_b64_tr_b16 a[188:189], v233 offset:14336
    ds_read_b64_tr_b16 a[190:191], v233 offset:15360
    v_mfma_f32_32x32x16_bf16 v[80:95], a[68:71], a[248:251], v[80:95]
    v_mfma_f32_32x32x16_bf16 v[96:111], a[68:71], a[252:255], v[96:111]
    s_add_u32 s0, s30, 32768
    buffer_load_dwordx4 a[240:243], v238, s[56:59], s0 offen offset:0 sc1
    buffer_load_dwordx4 a[244:247], v238, s[56:59], s0 offen offset:1024 sc1
    s_waitcnt vmcnt(32)
    v_mfma_f32_32x32x16_bf16 v[48:63], a[72:75], v[112:115], v[48:63]
    s_add_u32 m0, s78, 4096
    s_add_u32 s2, s77, 32768
    buffer_load_dwordx4 v164, s[68:71], s2 offen offset:0 lds
    v_mfma_f32_32x32x16_bf16 v[64:79], a[72:75], v[116:119], v[64:79]
    s_add_u32 s2, s77, 39936
    buffer_load_dwordx4 v165, s[68:71], s2 offen offset:1024 lds
    ds_read_b64_tr_b16 a[192:193], v232 offset:16384
    ds_read_b64_tr_b16 a[194:195], v232 offset:17408
    ds_read_b64_tr_b16 a[196:197], v233 offset:16384
    ds_read_b64_tr_b16 a[198:199], v233 offset:17408
    v_mfma_f32_32x32x16_bf16 v[80:95], a[76:79], v[112:115], v[80:95]
    v_mfma_f32_32x32x16_bf16 v[96:111], a[76:79], v[116:119], v[96:111]
    buffer_load_dwordx4 a[248:251], v238, s[56:59], s0 offen offset:2048 sc1
    buffer_load_dwordx4 a[252:255], v238, s[56:59], s0 offen offset:3072 sc1
    s_waitcnt vmcnt(32)
    v_mfma_f32_32x32x16_bf16 v[48:63], a[80:83], v[120:123], v[48:63]
    s_add_u32 s2, s77, 47104
    buffer_load_dwordx4 v164, s[68:71], s2 offen offset:2048 lds
    v_mfma_f32_32x32x16_bf16 v[64:79], a[80:83], v[124:127], v[64:79]
    s_add_u32 s2, s77, 54272
    buffer_load_dwordx4 v165, s[68:71], s2 offen offset:3072 lds
    ds_read_b64_tr_b16 a[200:201], v232 offset:18432
    ds_read_b64_tr_b16 a[202:203], v232 offset:19456
    ds_read_b64_tr_b16 a[204:205], v233 offset:18432
    ds_read_b64_tr_b16 a[206:207], v233 offset:19456
    v_mfma_f32_32x32x16_bf16 v[80:95], a[84:87], v[120:123], v[80:95]
    v_mfma_f32_32x32x16_bf16 v[96:111], a[84:87], v[124:127], v[96:111]
    s_add_u32 s0, s30, 36864
    buffer_load_dwordx4 v[112:115], v238, s[56:59], s0 offen offset:0 sc1
    buffer_load_dwordx4 v[116:119], v238, s[56:59], s0 offen offset:1024 sc1
    s_waitcnt vmcnt(16)
    s_barrier
    s_cmp_eq_u32 s5, 0
    s_cbranch_scc0 noflag_11
    s_lshl_b32 s86, s3, 4
    s_add_u32 s86, s86, s4
    s_lshl_b32 s86, s86, 7
    s_add_u32 s86, s86, 12910592
    v_mov_b32 v12, s90
    v_mov_b32 v13, s91
    s_mov_b64 s[42:43], exec
    s_mov_b64 exec, 1
    buffer_store_dwordx2 v[12:13], off, s[56:59], s86 sc1
    s_mov_b64 exec, s[42:43]
noflag_11:
    v_mfma_f32_32x32x16_bf16 v[48:63], a[88:91], v[128:131], v[48:63]
    s_add_u32 m0, s78, 8192
    s_add_u32 s2, s77, 128
    buffer_load_dwordx4 v164, s[64:67], s2 offen offset:0 lds
    v_mfma_f32_32x32x16_bf16 v[64:79], a[88:91], v[132:135], v[64:79]
    s_add_u32 s2, s77, 7296
    buffer_load_dwordx4 v165, s[64:67], s2 offen offset:1024 lds
    ds_read_b64_tr_b16 a[208:209], v232 offset:20480
    ds_read_b64_tr_b16 a[210:211], v232 offset:21504
    ds_read_b64_tr_b16 a[212:213], v233 offset:20480
    ds_read_b64_tr_b16 a[214:215], v233 offset:21504
    v_mfma_f32_32x32x16_bf16 v[80:95], a[92:95], v[128:131], v[80:95]
    v_mfma_f32_32x32x16_bf16 v[96:111], a[92:95], v[132:135], v[96:111]
    buffer_load_dwordx4 v[120:123], v238, s[56:59], s0 offen offset:2048 sc1
    buffer_load_dwordx4 v[124:127], v238, s[56:59], s0 offen offset:3072 sc1
    v_mfma_f32_32x32x16_bf16 v[48:63], a[96:99], v[136:139], v[48:63]
    s_add_u32 s2, s77, 14464
    buffer_load_dwordx4 v164, s[64:67], s2 offen offset:2048 lds
    v_mfma_f32_32x32x16_bf16 v[64:79], a[96:99], v[140:143], v[64:79]
    s_add_u32 s2, s77, 21632
    buffer_load_dwordx4 v165, s[64:67], s2 offen offset:3072 lds
    ds_read_b64_tr_b16 a[216:217], v232 offset:22528
    ds_read_b64_tr_b16 a[218:219], v232 offset:23552
    ds_read_b64_tr_b16 a[220:221], v233 offset:22528
    ds_read_b64_tr_b16 a[222:223], v233 offset:23552
    v_mfma_f32_32x32x16_bf16 v[80:95], a[100:103], v[136:139], v[80:95]
    v_mfma_f32_32x32x16_bf16 v[96:111], a[100:103], v[140:143], v[96:111]
    s_add_u32 s0, s30, 40960
    buffer_load_dwordx4 v[128:131], v238, s[56:59], s0 offen offset:0 sc1
    buffer_load_dwordx4 v[132:135], v238, s[56:59], s0 offen offset:1024 sc1
    v_mfma_f32_32x32x16_bf16 v[48:63], a[104:107], v[144:147], v[48:63]
    s_waitcnt lgkmcnt(15)
    s_add_u32 m0, s78, 12288
    s_add_u32 s2, s77, 32896
    buffer_load_dwordx4 v164, s[64:67], s2 offen offset:0 lds
    s_lshl_b32 s86, s95, 7
    v_mfma_f32_32x32x16_bf16 v[64:79], a[104:107], v[148:151], v[64:79]
    s_add_u32 s2, s77, 40064
    buffer_load_dwordx4 v165, s[64:67], s2 offen offset:1024 lds
    s_lshl_b32 s87, s96, 6
    s_add_u32 s86, s86, s87
    v_mfma_f32_32x32x16_bf16 v[80:95], a[108:111], v[144:147], v[80:95]
    s_lshl_b32 s87, s6, 4
    s_add_u32 s86, s86, s87
    v_mfma_f32_32x32x16_bf16 v[96:111], a[108:111], v[148:151], v[96:111]
    s_lshl_b32 s87, s7, 2
    s_add_u32 s86, s86, s87
    buffer_load_dwordx4 v[136:139], v238, s[56:59], s0 offen offset:2048 sc1
    buffer_load_dwordx4 v[140:143], v238, s[56:59], s0 offen offset:3072 sc1
    v_mfma_f32_32x32x16_bf16 v[48:63], a[112:115], a[224:227], v[48:63]
    s_add_u32 s2, s77, 47232
    buffer_load_dwordx4 v164, s[64:67], s2 offen offset:2048 lds
    v_bfe_u32 v12, v1, 4, 1
    v_mfma_f32_32x32x16_bf16 v[64:79], a[112:115], a[228:231], v[64:79]
    s_add_u32 s2, s77, 54400
    buffer_load_dwordx4 v165, s[64:67], s2 offen offset:3072 lds
    v_lshlrev_b32 v12, 3, v12
    v_lshrrev_b32 v13, 5, v1
    v_mfma_f32_32x32x16_bf16 v[80:95], a[116:119], a[224:227], v[80:95]
    v_add_u32 v12, v12, v13
    v_mfma_f32_32x32x16_bf16 v[96:111], a[116:119], a[228:231], v[96:111]
    v_add_u32 v12, s86, v12
    v_and_b32 v13, 15, v1
    s_add_u32 s0, s30, 45056
    buffer_load_dwordx4 v[144:147], v238, s[56:59], s0 offen offset:0 sc1
    buffer_load_dwordx4 v[148:151], v238, s[56:59], s0 offen offset:1024 sc1
    s_waitcnt vmcnt(28)
    v_mfma_f32_32x32x16_bf16 v[48:63], a[120:123], a[232:235], v[48:63]
    s_waitcnt lgkmcnt(12)
    s_add_u32 m0, s78, 16384
    s_add_u32 s2, s77, 128
    buffer_load_dwordx4 v164, s[68:71], s2 offen offset:0 lds
    s_lshl_b32 s87, s97, 4
    v_mfma_f32_32x32x16_bf16 v[64:79], a[120:123], a[236:239], v[64:79]
    s_add_u32 s2, s77, 7296
    buffer_load_dwordx4 v165, s[68:71], s2 offen offset:1024 lds
    v_add_u32 v13, s87, v13
    v_lshlrev_b32 v14, 10, v12
    v_mfma_f32_32x32x16_bf16 v[80:95], a[124:127], a[232:235], v[80:95]
    v_lshl_add_u32 v14, v13, 3, v14
    v_mfma_f32_32x32x16_bf16 v[96:111], a[124:127], a[236:239], v[96:111]
    v_lshlrev_b32 v15, 2, v12
    v_add_u32 v15, 12582912, v15
    buffer_load_dwordx4 a[224:227], v238, s[56:59], s0 offen offset:2048 sc1
    buffer_load_dwordx4 a[228:231], v238, s[56:59], s0 offen offset:3072 sc1
    s_waitcnt vmcnt(28)
    v_mfma_f32_32x32x16_bf16 v[48:63], a[128:131], a[240:243], v[48:63]
    s_waitcnt lgkmcnt(8)
    s_add_u32 s2, s77, 14464
    buffer_load_dwordx4 v164, s[68:71], s2 offen offset:2048 lds
    v_lshlrev_b32 v9, 11, v12
    v_mfma_f32_32x32x16_bf16 v[64:79], a[128:131], a[244:247], v[64:79]
    s_add_u32 s2, s77, 21632
    buffer_load_dwordx4 v165, s[68:71], s2 offen offset:3072 lds
    v_lshl_add_u32 v9, v13, 4, v9
    v_lshlrev_b32 v13, 3, v13
    v_mfma_f32_32x32x16_bf16 v[80:95], a[132:135], a[240:243], v[80:95]
    s_mov_b32 s87, 0
    buffer_load_dwordx2 v[152:153], v14, s[44:47], s87 offen
    v_mfma_f32_32x32x16_bf16 v[96:111], a[132:135], a[244:247], v[96:111]
    buffer_load_dword v2, v15, s[56:59], 0 offen offset:0 sc1
    s_mov_b32 s87, 32768
    buffer_load_dwordx2 v[154:155], v14, s[44:47], s87 offen
    s_add_u32 s0, s30, 49152
    buffer_load_dwordx4 a[232:235], v238, s[56:59], s0 offen offset:0 sc1
    buffer_load_dwordx4 a[236:239], v238, s[56:59], s0 offen offset:1024 sc1
    s_waitcnt vmcnt(31)
    v_mfma_f32_32x32x16_bf16 v[48:63], a[136:139], a[248:251], v[48:63]
    s_waitcnt lgkmcnt(4)
    s_add_u32 m0, s78, 20480
    s_add_u32 s2, s77, 32896
    buffer_load_dwordx4 v164, s[68:71], s2 offen offset:0 lds
    buffer_load_dword v3, v15, s[56:59], 0 offen offset:128 sc1
    v_mfma_f32_32x32x16_bf16 v[64:79], a[136:139], a[252:255], v[64:79]
    s_add_u32 s2, s77, 40064
    buffer_load_dwordx4 v165, s[68:71], s2 offen offset:1024 lds
    s_mov_b32 s87, 2048
    buffer_load_dwordx2 v[156:157], v14, s[44:47], s87 offen
    buffer_load_dword v4, v15, s[56:59], 0 offen offset:8 sc1
    v_mfma_f32_32x32x16_bf16 v[80:95], a[140:143], a[248:251], v[80:95]
    s_mov_b32 s87, 34816
    buffer_load_dwordx2 v[158:159], v14, s[44:47], s87 offen
    v_mfma_f32_32x32x16_bf16 v[96:111], a[140:143], a[252:255], v[96:111]
    buffer_load_dword v5, v15, s[56:59], 0 offen offset:136 sc1
    global_load_dwordx2 v[6:7], v13, s[24:25]
    buffer_load_dwordx4 a[240:243], v238, s[56:59], s0 offen offset:2048 sc1
    buffer_load_dwordx4 a[244:247], v238, s[56:59], s0 offen offset:3072 sc1
    s_mov_b32 s86, 12910592
    buffer_load_dwordx2 v[162:163], v239, s[56:59], s86 offen sc1
    s_waitcnt vmcnt(38)
    v_mfma_f32_32x32x16_bf16 v[48:63], a[144:147], v[112:115], v[48:63]
    s_waitcnt lgkmcnt(0)
    s_add_u32 s2, s77, 47232
    buffer_load_dwordx4 v164, s[68:71], s2 offen offset:2048 lds
    v_mfma_f32_32x32x16_bf16 v[64:79], a[144:147], v[116:119], v[64:79]
    s_add_u32 s2, s77, 54400
    buffer_load_dwordx4 v165, s[68:71], s2 offen offset:3072 lds
    v_mfma_f32_32x32x16_bf16 v[80:95], a[148:151], v[112:115], v[80:95]
    v_mfma_f32_32x32x16_bf16 v[96:111], a[148:151], v[116:119], v[96:111]
    s_add_u32 s0, s30, 53248
    buffer_load_dwordx4 a[248:251], v238, s[56:59], s0 offen offset:0 sc1
    buffer_load_dwordx4 a[252:255], v238, s[56:59], s0 offen offset:1024 sc1
    s_waitcnt vmcnt(38)
    v_mfma_f32_32x32x16_bf16 v[48:63], a[152:155], v[120:123], v[48:63]
    v_mfma_f32_32x32x16_bf16 v[64:79], a[152:155], v[124:127], v[64:79]
    v_mfma_f32_32x32x16_bf16 v[80:95], a[156:159], v[120:123], v[80:95]
    v_mfma_f32_32x32x16_bf16 v[96:111], a[156:159], v[124:127], v[96:111]
    buffer_load_dwordx4 v[112:115], v238, s[56:59], s0 offen offset:2048 sc1
    buffer_load_dwordx4 v[116:119], v238, s[56:59], s0 offen offset:3072 sc1
    s_waitcnt vmcnt(6)
    v_xor_b32 v162, s90, v162
    v_xor_b32 v163, s91, v163
    v_or_b32 v162, v162, v163
    v_cmp_ne_u32 vcc, 0, v162
    s_nop 0
    s_cbranch_vccz poll_ok_13
    s_mov_b32 s100, 0
    s_mov_b32 s86, 12910592
poll_12:
    buffer_load_dwordx2 v[162:163], v239, s[56:59], s86 offen sc1
    s_waitcnt vmcnt(0)
    v_xor_b32 v162, s90, v162
    v_xor_b32 v163, s91, v163
    v_or_b32 v162, v162, v163
    v_cmp_ne_u32 vcc, 0, v162
    s_add_u32 s100, s100, 1
    s_cmp_gt_u32 s100, 100000
    s_cbranch_scc1 poll_ok_13
    s_cbranch_vccnz poll_12
poll_ok_13:
    v_mfma_f32_32x32x16_bf16 v[48:63], a[160:163], v[128:131], v[48:63]
    v_lshlrev_b32 v10, 16, v6
    v_and_b32 v11, 0xffff0000, v6
    v_mfma_f32_32x32x16_bf16 v[64:79], a[160:163], v[132:135], v[64:79]
    v_lshlrev_b32 v14, 16, v7
    v_and_b32 v15, 0xffff0000, v7
    v_lshlrev_b32 v240, 16, v152
    v_mfma_f32_32x32x16_bf16 v[80:95], a[164:167], v[128:131], v[80:95]
    v_and_b32 v241, 0xffff0000, v152
    v_lshlrev_b32 v242, 16, v153
    v_mfma_f32_32x32x16_bf16 v[96:111], a[164:167], v[132:135], v[96:111]
    v_and_b32 v243, 0xffff0000, v153
    v_mul_f32 v240, v240, v10
    v_mul_f32 v241, v241, v11
    s_add_u32 s0, s31, 0
    buffer_load_dwordx4 a[0:3], v238, s[56:59], s0 offen offset:0 sc1
    buffer_load_dwordx4 a[4:7], v238, s[56:59], s0 offen offset:1024 sc1
    v_mfma_f32_32x32x16_bf16 v[48:63], a[168:171], v[136:139], v[48:63]
    v_mul_f32 v242, v242, v14
    v_mul_f32 v243, v243, v15
    v_mfma_f32_32x32x16_bf16 v[64:79], a[168:171], v[140:143], v[64:79]
    v_mul_f32 v240, v240, v2
    v_mul_f32 v241, v241, v2
    v_mul_f32 v242, v242, v2
    v_mfma_f32_32x32x16_bf16 v[80:95], a[172:175], v[136:139], v[80:95]
    v_mul_f32 v243, v243, v2
    v_lshlrev_b32 v244, 16, v154
    v_mfma_f32_32x32x16_bf16 v[96:111], a[172:175], v[140:143], v[96:111]
    v_and_b32 v245, 0xffff0000, v154
    v_lshlrev_b32 v246, 16, v155
    v_and_b32 v247, 0xffff0000, v155
    buffer_load_dwordx4 a[8:11], v238, s[56:59], s0 offen offset:2048 sc1
    buffer_load_dwordx4 a[12:15], v238, s[56:59], s0 offen offset:3072 sc1
    v_mfma_f32_32x32x16_bf16 v[48:63], a[176:179], v[144:147], v[48:63]
    v_mul_f32 v244, v244, v10
    v_mul_f32 v245, v245, v11
    v_mfma_f32_32x32x16_bf16 v[64:79], a[176:179], v[148:151], v[64:79]
    v_mul_f32 v246, v246, v14
    v_mul_f32 v247, v247, v15
    v_mul_f32 v244, v244, v3
    v_mfma_f32_32x32x16_bf16 v[80:95], a[180:183], v[144:147], v[80:95]
    v_mul_f32 v245, v245, v3
    v_mul_f32 v246, v246, v3
    v_mfma_f32_32x32x16_bf16 v[96:111], a[180:183], v[148:151], v[96:111]
    v_mul_f32 v247, v247, v3
    v_lshlrev_b32 v248, 16, v156
    v_and_b32 v249, 0xffff0000, v156
    s_add_u32 s0, s31, 4096
    buffer_load_dwordx4 a[16:19], v238, s[56:59], s0 offen offset:0 sc1
    buffer_load_dwordx4 a[20:23], v238, s[56:59], s0 offen offset:1024 sc1
    v_mfma_f32_32x32x16_bf16 v[48:63], a[184:187], a[224:227], v[48:63]
    v_lshlrev_b32 v250, 16, v157
    v_and_b32 v251, 0xffff0000, v157
    v_mfma_f32_32x32x16_bf16 v[64:79], a[184:187], a[228:231], v[64:79]
    v_mul_f32 v248, v248, v10
    v_mul_f32 v249, v249, v11
    v_mul_f32 v250, v250, v14
    v_mfma_f32_32x32x16_bf16 v[80:95], a[188:191], a[224:227], v[80:95]
    v_mul_f32 v251, v251, v15
    v_mul_f32 v248, v248, v4
    v_mfma_f32_32x32x16_bf16 v[96:111], a[188:191], a[228:231], v[96:111]
    v_mul_f32 v249, v249, v4
    v_mul_f32 v250, v250, v4
    v_mul_f32 v251, v251, v4
    buffer_load_dwordx4 a[24:27], v238, s[56:59], s0 offen offset:2048 sc1
    buffer_load_dwordx4 a[28:31], v238, s[56:59], s0 offen offset:3072 sc1
    v_mfma_f32_32x32x16_bf16 v[48:63], a[192:195], a[232:235], v[48:63]
    v_lshlrev_b32 v252, 16, v158
    v_and_b32 v253, 0xffff0000, v158
    v_mfma_f32_32x32x16_bf16 v[64:79], a[192:195], a[236:239], v[64:79]
    v_lshlrev_b32 v254, 16, v159
    v_and_b32 v255, 0xffff0000, v159
    v_mul_f32 v252, v252, v10
    v_mfma_f32_32x32x16_bf16 v[80:95], a[196:199], a[232:235], v[80:95]
    v_mul_f32 v253, v253, v11
    v_mul_f32 v254, v254, v14
    v_mfma_f32_32x32x16_bf16 v[96:111], a[196:199], a[236:239], v[96:111]
    v_mul_f32 v255, v255, v15
    v_mul_f32 v252, v252, v5
    v_mul_f32 v253, v253, v5
    s_add_u32 s0, s31, 8192
    buffer_load_dwordx4 a[32:35], v238, s[56:59], s0 offen offset:0 sc1
    buffer_load_dwordx4 a[36:39], v238, s[56:59], s0 offen offset:1024 sc1
    v_mfma_f32_32x32x16_bf16 v[48:63], a[200:203], a[240:243], v[48:63]
    v_mul_f32 v254, v254, v5
    v_mul_f32 v255, v255, v5
    v_mfma_f32_32x32x16_bf16 v[64:79], a[200:203], a[244:247], v[64:79]
    v_and_b32 v2, 31, v1
    v_lshrrev_b32 v3, 5, v1
    v_mfma_f32_32x32x16_bf16 v[80:95], a[204:207], a[240:243], v[80:95]
    v_and_b32 v4, 7, v1
    v_xor_b32 v4, v4, v3
    v_mfma_f32_32x32x16_bf16 v[96:111], a[204:207], a[244:247], v[96:111]
    v_lshlrev_b32 v5, 8, v2
    v_add_u32 v5, s78, v5
    v_xor_b32 v6, 0, v4
    buffer_load_dwordx4 a[40:43], v238, s[56:59], s0 offen offset:2048 sc1
    buffer_load_dwordx4 a[44:47], v238, s[56:59], s0 offen offset:3072 sc1
    s_waitcnt vmcnt(14)
    v_mfma_f32_32x32x16_bf16 v[48:63], a[208:211], a[248:251], v[48:63]
    v_lshl_add_u32 v156, v6, 4, v5
    v_xor_b32 v6, 2, v4
    v_mfma_f32_32x32x16_bf16 v[64:79], a[208:211], a[252:255], v[64:79]
    v_lshl_add_u32 v157, v6, 4, v5
    v_xor_b32 v6, 4, v4
    v_mfma_f32_32x32x16_bf16 v[80:95], a[212:215], a[248:251], v[80:95]
    v_lshl_add_u32 v158, v6, 4, v5
    v_xor_b32 v6, 6, v4
    v_mfma_f32_32x32x16_bf16 v[96:111], a[212:215], a[252:255], v[96:111]
    v_lshl_add_u32 v159, v6, 4, v5
    v_lshrrev_b32 v2, 4, v1
    v_and_b32 v3, 15, v1
    s_add_u32 s0, s31, 12288
    buffer_load_dwordx4 a[48:51], v238, s[56:59], s0 offen offset:0 sc1
    buffer_load_dwordx4 a[52:55], v238, s[56:59], s0 offen offset:1024 sc1
    s_waitcnt vmcnt(14)
    v_mfma_f32_32x32x16_bf16 v[48:63], a[216:219], v[112:115], v[48:63]
    v_xor_b32 v3, v3, v2
    s_lshl_b32 s86, s5, 12
    v_lshlrev_b32 v4, 8, v2
    v_add_u32 v4, s86, v4
    v_mfma_f32_32x32x16_bf16 v[64:79], a[216:219], v[116:119], v[64:79]
    v_lshl_add_u32 v5, v3, 4, v4
    v_xor_b32 v3, 4, v3
    v_mfma_f32_32x32x16_bf16 v[80:95], a[220:223], v[112:115], v[80:95]
    v_lshl_add_u32 v6, v3, 4, v4
    v_add_u32 v7, 0x10000, v5
    v_mfma_f32_32x32x16_bf16 v[96:111], a[220:223], v[116:119], v[96:111]
    v_add_u32 v8, 0x10000, v6
    v_sub_f32 v12, 1.0, v160
    v_sub_f32 v13, 1.0, v161
    buffer_load_dwordx4 a[56:59], v238, s[56:59], s0 offen offset:2048 sc1
    buffer_load_dwordx4 a[60:63], v238, s[56:59], s0 offen offset:3072 sc1
    ds_read_b128 v[16:19], v234 offset:24576
    ds_read_b128 v[24:27], v234 offset:0
    ds_read_b128 v[20:23], v234 offset:28672
    ds_read_b128 v[28:31], v234 offset:4096
    s_waitcnt lgkmcnt(2)
    v_perm_b32 v112, v24, v16, s98
    v_perm_b32 v113, v24, v16, s99
    v_perm_b32 v114, v25, v17, s98
    v_perm_b32 v115, v25, v17, s99
    s_waitcnt lgkmcnt(0)
    v_perm_b32 v116, v28, v20, s98
    v_perm_b32 v117, v28, v20, s99
    v_perm_b32 v118, v29, v21, s98
    v_perm_b32 v119, v29, v21, s99
    s_waitcnt vmcnt(14)
    v_mfma_f32_32x32x16_bf16 v[168:183], v[112:115], a[0:3], 0
    v_perm_b32 v120, v26, v18, s98
    v_perm_b32 v121, v26, v18, s99
    v_perm_b32 v122, v27, v19, s98
    v_perm_b32 v123, v27, v19, s99
    v_mfma_f32_32x32x16_bf16 v[184:199], v[112:115], a[4:7], 0
    v_perm_b32 v124, v30, v22, s98
    v_perm_b32 v125, v30, v22, s99
    v_perm_b32 v126, v31, v23, s98
    v_perm_b32 v127, v31, v23, s99
    v_mfma_f32_32x32x16_bf16 v[200:215], v[116:119], a[0:3], 0
    ds_read_b128 v[32:35], v235 offset:24576
    ds_read_b128 v[40:43], v235 offset:0
    v_mfma_f32_32x32x16_bf16 v[216:231], v[116:119], a[4:7], 0
    ds_read_b128 v[36:39], v235 offset:28672
    ds_read_b128 v[44:47], v235 offset:4096
    s_waitcnt vmcnt(12)
    v_mfma_f32_32x32x16_bf16 v[168:183], v[120:123], a[8:11], v[168:183]
    s_add_u32 s0, s31, 16384
    buffer_load_dwordx4 a[64:67], v238, s[56:59], s0 offen offset:0 sc1
    v_mfma_f32_32x32x16_bf16 v[184:199], v[120:123], a[12:15], v[184:199]
    buffer_load_dwordx4 a[68:71], v238, s[56:59], s0 offen offset:1024 sc1
    v_mfma_f32_32x32x16_bf16 v[200:215], v[124:127], a[8:11], v[200:215]
    buffer_load_dwordx4 a[72:75], v238, s[56:59], s0 offen offset:2048 sc1
    v_mfma_f32_32x32x16_bf16 v[216:231], v[124:127], a[12:15], v[216:231]
    buffer_load_dwordx4 a[76:79], v238, s[56:59], s0 offen offset:3072 sc1
    s_waitcnt lgkmcnt(2)
    v_perm_b32 v112, v40, v32, s98
    v_perm_b32 v113, v40, v32, s99
    v_perm_b32 v114, v41, v33, s98
    v_perm_b32 v115, v41, v33, s99
    s_waitcnt lgkmcnt(0)
    v_perm_b32 v116, v44, v36, s98
    v_perm_b32 v117, v44, v36, s99
    v_perm_b32 v118, v45, v37, s98
    v_perm_b32 v119, v45, v37, s99
    s_waitcnt vmcnt(14)
    v_mfma_f32_32x32x16_bf16 v[168:183], v[112:115], a[16:19], v[168:183]
    v_perm_b32 v120, v42, v34, s98
    v_perm_b32 v121, v42, v34, s99
    v_perm_b32 v122, v43, v35, s98
    v_perm_b32 v123, v43, v35, s99
    v_mfma_f32_32x32x16_bf16 v[184:199], v[112:115], a[20:23], v[184:199]
    v_perm_b32 v124, v46, v38, s98
    v_perm_b32 v125, v46, v38, s99
    v_perm_b32 v126, v47, v39, s98
    v_perm_b32 v127, v47, v39, s99
    v_mfma_f32_32x32x16_bf16 v[200:215], v[116:119], a[16:19], v[200:215]
    ds_read_b128 v[16:19], v236 offset:24576
    ds_read_b128 v[24:27], v236 offset:0
    v_mfma_f32_32x32x16_bf16 v[216:231], v[116:119], a[20:23], v[216:231]
    ds_read_b128 v[20:23], v236 offset:28672
    ds_read_b128 v[28:31], v236 offset:4096
    s_waitcnt vmcnt(12)
    v_mfma_f32_32x32x16_bf16 v[168:183], v[120:123], a[24:27], v[168:183]
    s_add_u32 s0, s31, 20480
    buffer_load_dwordx4 a[80:83], v238, s[56:59], s0 offen offset:0 sc1
    v_mfma_f32_32x32x16_bf16 v[184:199], v[120:123], a[28:31], v[184:199]
    buffer_load_dwordx4 a[84:87], v238, s[56:59], s0 offen offset:1024 sc1
    v_mfma_f32_32x32x16_bf16 v[200:215], v[124:127], a[24:27], v[200:215]
    buffer_load_dwordx4 a[88:91], v238, s[56:59], s0 offen offset:2048 sc1
    v_mfma_f32_32x32x16_bf16 v[216:231], v[124:127], a[28:31], v[216:231]
    buffer_load_dwordx4 a[92:95], v238, s[56:59], s0 offen offset:3072 sc1
    s_waitcnt lgkmcnt(2)
    v_perm_b32 v112, v24, v16, s98
    v_perm_b32 v113, v24, v16, s99
    v_perm_b32 v114, v25, v17, s98
    v_perm_b32 v115, v25, v17, s99
    s_waitcnt lgkmcnt(0)
    v_perm_b32 v116, v28, v20, s98
    v_perm_b32 v117, v28, v20, s99
    v_perm_b32 v118, v29, v21, s98
    v_perm_b32 v119, v29, v21, s99
    s_waitcnt vmcnt(14)
    v_mfma_f32_32x32x16_bf16 v[168:183], v[112:115], a[32:35], v[168:183]
    v_perm_b32 v120, v26, v18, s98
    v_perm_b32 v121, v26, v18, s99
    v_perm_b32 v122, v27, v19, s98
    v_perm_b32 v123, v27, v19, s99
    v_mfma_f32_32x32x16_bf16 v[184:199], v[112:115], a[36:39], v[184:199]
    v_perm_b32 v124, v30, v22, s98
    v_perm_b32 v125, v30, v22, s99
    v_perm_b32 v126, v31, v23, s98
    v_perm_b32 v127, v31, v23, s99
    v_mfma_f32_32x32x16_bf16 v[200:215], v[116:119], a[32:35], v[200:215]
    ds_read_b128 v[32:35], v237 offset:24576
    ds_read_b128 v[40:43], v237 offset:0
    v_mfma_f32_32x32x16_bf16 v[216:231], v[116:119], a[36:39], v[216:231]
    ds_read_b128 v[36:39], v237 offset:28672
    ds_read_b128 v[44:47], v237 offset:4096
    s_waitcnt vmcnt(12)
    v_mfma_f32_32x32x16_bf16 v[168:183], v[120:123], a[40:43], v[168:183]
    s_add_u32 s0, s31, 24576
    buffer_load_dwordx4 a[96:99], v238, s[56:59], s0 offen offset:0 sc1
    v_mfma_f32_32x32x16_bf16 v[184:199], v[120:123], a[44:47], v[184:199]
    buffer_load_dwordx4 a[100:103], v238, s[56:59], s0 offen offset:1024 sc1
    v_mfma_f32_32x32x16_bf16 v[200:215], v[124:127], a[40:43], v[200:215]
    buffer_load_dwordx4 a[104:107], v238, s[56:59], s0 offen offset:2048 sc1
    v_mfma_f32_32x32x16_bf16 v[216:231], v[124:127], a[44:47], v[216:231]
    buffer_load_dwordx4 a[108:111], v238, s[56:59], s0 offen offset:3072 sc1
    s_waitcnt lgkmcnt(2)
    v_perm_b32 v112, v40, v32, s98
    v_perm_b32 v113, v40, v32, s99
    v_perm_b32 v114, v41, v33, s98
    v_perm_b32 v115, v41, v33, s99
    s_waitcnt lgkmcnt(0)
    v_perm_b32 v116, v44, v36, s98
    v_perm_b32 v117, v44, v36, s99
    v_perm_b32 v118, v45, v37, s98
    v_perm_b32 v119, v45, v37, s99
    s_waitcnt vmcnt(14)
    v_mfma_f32_32x32x16_bf16 v[168:183], v[112:115], a[48:51], v[168:183]
    v_perm_b32 v120, v42, v34, s98
    v_perm_b32 v121, v42, v34, s99
    v_perm_b32 v122, v43, v35, s98
    v_perm_b32 v123, v43, v35, s99
    v_mfma_f32_32x32x16_bf16 v[184:199], v[112:115], a[52:55], v[184:199]
    v_perm_b32 v124, v46, v38, s98
    v_perm_b32 v125, v46, v38, s99
    v_perm_b32 v126, v47, v39, s98
    v_perm_b32 v127, v47, v39, s99
    v_mfma_f32_32x32x16_bf16 v[200:215], v[116:119], a[48:51], v[200:215]
    ds_read_b128 v[16:19], v234 offset:8192
    ds_read_b128 v[24:27], v234 offset:16384
    v_mfma_f32_32x32x16_bf16 v[216:231], v[116:119], a[52:55], v[216:231]
    ds_read_b128 v[20:23], v234 offset:12288
    ds_read_b128 v[28:31], v234 offset:20480
    s_waitcnt vmcnt(12)
    v_mfma_f32_32x32x16_bf16 v[168:183], v[120:123], a[56:59], v[168:183]
    s_add_u32 s0, s31, 28672
    buffer_load_dwordx4 a[112:115], v238, s[56:59], s0 offen offset:0 sc1
    v_mfma_f32_32x32x16_bf16 v[184:199], v[120:123], a[60:63], v[184:199]
    buffer_load_dwordx4 a[116:119], v238, s[56:59], s0 offen offset:1024 sc1
    v_mfma_f32_32x32x16_bf16 v[200:215], v[124:127], a[56:59], v[200:215]
    buffer_load_dwordx4 a[120:123], v238, s[56:59], s0 offen offset:2048 sc1
    v_mfma_f32_32x32x16_bf16 v[216:231], v[124:127], a[60:63], v[216:231]
    buffer_load_dwordx4 a[124:127], v238, s[56:59], s0 offen offset:3072 sc1
    s_waitcnt lgkmcnt(2)
    v_perm_b32 v112, v24, v16, s98
    v_perm_b32 v113, v24, v16, s99
    v_perm_b32 v114, v25, v17, s98
    v_perm_b32 v115, v25, v17, s99
    s_waitcnt lgkmcnt(0)
    v_perm_b32 v116, v28, v20, s98
    v_perm_b32 v117, v28, v20, s99
    v_perm_b32 v118, v29, v21, s98
    v_perm_b32 v119, v29, v21, s99
    s_waitcnt vmcnt(14)
    v_mfma_f32_32x32x16_bf16 v[168:183], v[112:115], a[64:67], v[168:183]
    v_perm_b32 v120, v26, v18, s98
    v_perm_b32 v121, v26, v18, s99
    v_perm_b32 v122, v27, v19, s98
    v_perm_b32 v123, v27, v19, s99
    v_mfma_f32_32x32x16_bf16 v[184:199], v[112:115], a[68:71], v[184:199]
    v_perm_b32 v124, v30, v22, s98
    v_perm_b32 v125, v30, v22, s99
    v_perm_b32 v126, v31, v23, s98
    v_perm_b32 v127, v31, v23, s99
    v_mfma_f32_32x32x16_bf16 v[200:215], v[116:119], a[64:67], v[200:215]
    ds_read_b128 v[32:35], v235 offset:8192
    ds_read_b128 v[40:43], v235 offset:16384
    v_mfma_f32_32x32x16_bf16 v[216:231], v[116:119], a[68:71], v[216:231]
    ds_read_b128 v[36:39], v235 offset:12288
    ds_read_b128 v[44:47], v235 offset:20480
    s_waitcnt vmcnt(12)
    v_mfma_f32_32x32x16_bf16 v[168:183], v[120:123], a[72:75], v[168:183]
    v_mfma_f32_32x32x16_bf16 v[184:199], v[120:123], a[76:79], v[184:199]
    v_mfma_f32_32x32x16_bf16 v[200:215], v[124:127], a[72:75], v[200:215]
    v_mfma_f32_32x32x16_bf16 v[216:231], v[124:127], a[76:79], v[216:231]
    s_waitcnt lgkmcnt(2)
    v_perm_b32 v112, v40, v32, s98
    v_perm_b32 v113, v40, v32, s99
    v_perm_b32 v114, v41, v33, s98
    v_perm_b32 v115, v41, v33, s99
    s_waitcnt lgkmcnt(0)
    v_perm_b32 v116, v44, v36, s98
    v_perm_b32 v117, v44, v36, s99
    v_perm_b32 v118, v45, v37, s98
    v_perm_b32 v119, v45, v37, s99
    s_waitcnt vmcnt(10)
    v_mfma_f32_32x32x16_bf16 v[168:183], v[112:115], a[80:83], v[168:183]
    v_perm_b32 v120, v42, v34, s98
    v_perm_b32 v121, v42, v34, s99
    v_perm_b32 v122, v43, v35, s98
    v_perm_b32 v123, v43, v35, s99
    v_mfma_f32_32x32x16_bf16 v[184:199], v[112:115], a[84:87], v[184:199]
    v_perm_b32 v124, v46, v38, s98
    v_perm_b32 v125, v46, v38, s99
    v_perm_b32 v126, v47, v39, s98
    v_perm_b32 v127, v47, v39, s99
    v_mfma_f32_32x32x16_bf16 v[200:215], v[116:119], a[80:83], v[200:215]
    ds_read_b128 v[16:19], v236 offset:8192
    ds_read_b128 v[24:27], v236 offset:16384
    v_mfma_f32_32x32x16_bf16 v[216:231], v[116:119], a[84:87], v[216:231]
    ds_read_b128 v[20:23], v236 offset:12288
    ds_read_b128 v[28:31], v236 offset:20480
    s_waitcnt vmcnt(8)
    v_mfma_f32_32x32x16_bf16 v[168:183], v[120:123], a[88:91], v[168:183]
    v_mfma_f32_32x32x16_bf16 v[184:199], v[120:123], a[92:95], v[184:199]
    v_mfma_f32_32x32x16_bf16 v[200:215], v[124:127], a[88:91], v[200:215]
    v_mfma_f32_32x32x16_bf16 v[216:231], v[124:127], a[92:95], v[216:231]
    s_waitcnt lgkmcnt(2)
    v_perm_b32 v112, v24, v16, s98
    v_perm_b32 v113, v24, v16, s99
    v_perm_b32 v114, v25, v17, s98
    v_perm_b32 v115, v25, v17, s99
    s_waitcnt lgkmcnt(0)
    v_perm_b32 v116, v28, v20, s98
    v_perm_b32 v117, v28, v20, s99
    v_perm_b32 v118, v29, v21, s98
    v_perm_b32 v119, v29, v21, s99
    s_waitcnt vmcnt(6)
    v_mfma_f32_32x32x16_bf16 v[168:183], v[112:115], a[96:99], v[168:183]
    v_perm_b32 v120, v26, v18, s98
    v_perm_b32 v121, v26, v18, s99
    v_perm_b32 v122, v27, v19, s98
    v_perm_b32 v123, v27, v19, s99
    v_mfma_f32_32x32x16_bf16 v[184:199], v[112:115], a[100:103], v[184:199]
    v_perm_b32 v124, v30, v22, s98
    v_perm_b32 v125, v30, v22, s99
    v_perm_b32 v126, v31, v23, s98
    v_perm_b32 v127, v31, v23, s99
    v_mfma_f32_32x32x16_bf16 v[200:215], v[116:119], a[96:99], v[200:215]
    ds_read_b128 v[32:35], v237 offset:8192
    ds_read_b128 v[40:43], v237 offset:16384
    v_mfma_f32_32x32x16_bf16 v[216:231], v[116:119], a[100:103], v[216:231]
    ds_read_b128 v[36:39], v237 offset:12288
    ds_read_b128 v[44:47], v237 offset:20480
    s_waitcnt vmcnt(4)
    v_mfma_f32_32x32x16_bf16 v[168:183], v[120:123], a[104:107], v[168:183]
    v_mfma_f32_32x32x16_bf16 v[184:199], v[120:123], a[108:111], v[184:199]
    v_mfma_f32_32x32x16_bf16 v[200:215], v[124:127], a[104:107], v[200:215]
    v_mfma_f32_32x32x16_bf16 v[216:231], v[124:127], a[108:111], v[216:231]
    s_waitcnt lgkmcnt(2)
    v_perm_b32 v112, v40, v32, s98
    v_perm_b32 v113, v40, v32, s99
    v_perm_b32 v114, v41, v33, s98
    v_perm_b32 v115, v41, v33, s99
    s_waitcnt lgkmcnt(0)
    v_perm_b32 v116, v44, v36, s98
    v_perm_b32 v117, v44, v36, s99
    v_perm_b32 v118, v45, v37, s98
    v_perm_b32 v119, v45, v37, s99
    s_waitcnt vmcnt(2)
    v_mfma_f32_32x32x16_bf16 v[168:183], v[112:115], a[112:115], v[168:183]
    v_perm_b32 v120, v42, v34, s98
    v_perm_b32 v121, v42, v34, s99
    v_perm_b32 v122, v43, v35, s98
    v_perm_b32 v123, v43, v35, s99
    v_mfma_f32_32x32x16_bf16 v[184:199], v[112:115], a[116:119], v[184:199]
    v_perm_b32 v124, v46, v38, s98
    v_perm_b32 v125, v46, v38, s99
    v_perm_b32 v126, v47, v39, s98
    v_perm_b32 v127, v47, v39, s99
    v_mfma_f32_32x32x16_bf16 v[200:215], v[116:119], a[112:115], v[200:215]
    v_mfma_f32_32x32x16_bf16 v[216:231], v[116:119], a[116:119], v[216:231]
    s_waitcnt vmcnt(0)
    v_mfma_f32_32x32x16_bf16 v[168:183], v[120:123], a[120:123], v[168:183]
    v_mfma_f32_32x32x16_bf16 v[184:199], v[120:123], a[124:127], v[184:199]
    v_mfma_f32_32x32x16_bf16 v[200:215], v[124:127], a[120:123], v[200:215]
    v_mfma_f32_32x32x16_bf16 v[216:231], v[124:127], a[124:127], v[216:231]
    v_pk_mul_f32 v[48:49], v[48:49], v[12:13] op_sel:[0,0] op_sel_hi:[1,0]
    s_nop 7
    v_pk_fma_f32 v[48:49], v[168:169], v[160:161], v[48:49] op_sel:[0,0,0] op_sel_hi:[1,0,1]
    v_pk_mul_f32 v[50:51], v[50:51], v[12:13] op_sel:[0,0] op_sel_hi:[1,0]
    v_pk_fma_f32 v[50:51], v[170:171], v[160:161], v[50:51] op_sel:[0,0,0] op_sel_hi:[1,0,1]
    ds_write_b128 v156, v[48:51] offset:0
    v_pk_mul_f32 v[52:53], v[52:53], v[12:13] op_sel:[0,0] op_sel_hi:[1,0]
    v_pk_fma_f32 v[52:53], v[172:173], v[160:161], v[52:53] op_sel:[0,0,0] op_sel_hi:[1,0,1]
    v_pk_mul_f32 v[54:55], v[54:55], v[12:13] op_sel:[0,0] op_sel_hi:[1,0]
    v_pk_fma_f32 v[54:55], v[174:175], v[160:161], v[54:55] op_sel:[0,0,0] op_sel_hi:[1,0,1]
    ds_write_b128 v157, v[52:55] offset:0
    v_pk_mul_f32 v[56:57], v[56:57], v[12:13] op_sel:[0,0] op_sel_hi:[1,0]
    v_pk_fma_f32 v[56:57], v[176:177], v[160:161], v[56:57] op_sel:[0,0,0] op_sel_hi:[1,0,1]
    v_pk_mul_f32 v[58:59], v[58:59], v[12:13] op_sel:[0,0] op_sel_hi:[1,0]
    v_pk_fma_f32 v[58:59], v[178:179], v[160:161], v[58:59] op_sel:[0,0,0] op_sel_hi:[1,0,1]
    ds_write_b128 v158, v[56:59] offset:0
    v_pk_mul_f32 v[60:61], v[60:61], v[12:13] op_sel:[0,0] op_sel_hi:[1,0]
    v_pk_fma_f32 v[60:61], v[180:181], v[160:161], v[60:61] op_sel:[0,0,0] op_sel_hi:[1,0,1]
    v_pk_mul_f32 v[62:63], v[62:63], v[12:13] op_sel:[0,0] op_sel_hi:[1,0]
    v_pk_fma_f32 v[62:63], v[182:183], v[160:161], v[62:63] op_sel:[0,0,0] op_sel_hi:[1,0,1]
    ds_write_b128 v159, v[60:63] offset:0
    v_pk_mul_f32 v[64:65], v[64:65], v[12:13] op_sel:[0,1] op_sel_hi:[1,1]
    v_pk_fma_f32 v[64:65], v[184:185], v[160:161], v[64:65] op_sel:[0,1,0] op_sel_hi:[1,1,1]
    v_pk_mul_f32 v[66:67], v[66:67], v[12:13] op_sel:[0,1] op_sel_hi:[1,1]
    v_pk_fma_f32 v[66:67], v[186:187], v[160:161], v[66:67] op_sel:[0,1,0] op_sel_hi:[1,1,1]
    ds_write_b128 v156, v[64:67] offset:8192
    v_pk_mul_f32 v[68:69], v[68:69], v[12:13] op_sel:[0,1] op_sel_hi:[1,1]
    v_pk_fma_f32 v[68:69], v[188:189], v[160:161], v[68:69] op_sel:[0,1,0] op_sel_hi:[1,1,1]
    v_pk_mul_f32 v[70:71], v[70:71], v[12:13] op_sel:[0,1] op_sel_hi:[1,1]
    v_pk_fma_f32 v[70:71], v[190:191], v[160:161], v[70:71] op_sel:[0,1,0] op_sel_hi:[1,1,1]
    ds_write_b128 v157, v[68:71] offset:8192
    v_pk_mul_f32 v[72:73], v[72:73], v[12:13] op_sel:[0,1] op_sel_hi:[1,1]
    v_pk_fma_f32 v[72:73], v[192:193], v[160:161], v[72:73] op_sel:[0,1,0] op_sel_hi:[1,1,1]
    v_pk_mul_f32 v[74:75], v[74:75], v[12:13] op_sel:[0,1] op_sel_hi:[1,1]
    v_pk_fma_f32 v[74:75], v[194:195], v[160:161], v[74:75] op_sel:[0,1,0] op_sel_hi:[1,1,1]
    ds_write_b128 v158, v[72:75] offset:8192
    v_pk_mul_f32 v[76:77], v[76:77], v[12:13] op_sel:[0,1] op_sel_hi:[1,1]
    v_pk_fma_f32 v[76:77], v[196:197], v[160:161], v[76:77] op_sel:[0,1,0] op_sel_hi:[1,1,1]
    v_pk_mul_f32 v[78:79], v[78:79], v[12:13] op_sel:[0,1] op_sel_hi:[1,1]
    v_pk_fma_f32 v[78:79], v[198:199], v[160:161], v[78:79] op_sel:[0,1,0] op_sel_hi:[1,1,1]
    ds_write_b128 v159, v[76:79] offset:8192
    v_pk_mul_f32 v[80:81], v[80:81], v[12:13] op_sel:[0,0] op_sel_hi:[1,0]
    v_pk_fma_f32 v[80:81], v[200:201], v[160:161], v[80:81] op_sel:[0,0,0] op_sel_hi:[1,0,1]
    v_pk_mul_f32 v[82:83], v[82:83], v[12:13] op_sel:[0,0] op_sel_hi:[1,0]
    v_pk_fma_f32 v[82:83], v[202:203], v[160:161], v[82:83] op_sel:[0,0,0] op_sel_hi:[1,0,1]
    ds_write_b128 v156, v[80:83] offset:128
    v_pk_mul_f32 v[84:85], v[84:85], v[12:13] op_sel:[0,0] op_sel_hi:[1,0]
    v_pk_fma_f32 v[84:85], v[204:205], v[160:161], v[84:85] op_sel:[0,0,0] op_sel_hi:[1,0,1]
    v_pk_mul_f32 v[86:87], v[86:87], v[12:13] op_sel:[0,0] op_sel_hi:[1,0]
    v_pk_fma_f32 v[86:87], v[206:207], v[160:161], v[86:87] op_sel:[0,0,0] op_sel_hi:[1,0,1]
    ds_write_b128 v157, v[84:87] offset:128
    v_pk_mul_f32 v[88:89], v[88:89], v[12:13] op_sel:[0,0] op_sel_hi:[1,0]
    v_pk_fma_f32 v[88:89], v[208:209], v[160:161], v[88:89] op_sel:[0,0,0] op_sel_hi:[1,0,1]
    v_pk_mul_f32 v[90:91], v[90:91], v[12:13] op_sel:[0,0] op_sel_hi:[1,0]
    v_pk_fma_f32 v[90:91], v[210:211], v[160:161], v[90:91] op_sel:[0,0,0] op_sel_hi:[1,0,1]
    ds_write_b128 v158, v[88:91] offset:128
    v_pk_mul_f32 v[92:93], v[92:93], v[12:13] op_sel:[0,0] op_sel_hi:[1,0]
    v_pk_fma_f32 v[92:93], v[212:213], v[160:161], v[92:93] op_sel:[0,0,0] op_sel_hi:[1,0,1]
    v_pk_mul_f32 v[94:95], v[94:95], v[12:13] op_sel:[0,0] op_sel_hi:[1,0]
    v_pk_fma_f32 v[94:95], v[214:215], v[160:161], v[94:95] op_sel:[0,0,0] op_sel_hi:[1,0,1]
    ds_write_b128 v159, v[92:95] offset:128
    v_pk_mul_f32 v[96:97], v[96:97], v[12:13] op_sel:[0,1] op_sel_hi:[1,1]
    v_pk_fma_f32 v[96:97], v[216:217], v[160:161], v[96:97] op_sel:[0,1,0] op_sel_hi:[1,1,1]
    v_pk_mul_f32 v[98:99], v[98:99], v[12:13] op_sel:[0,1] op_sel_hi:[1,1]
    v_pk_fma_f32 v[98:99], v[218:219], v[160:161], v[98:99] op_sel:[0,1,0] op_sel_hi:[1,1,1]
    ds_write_b128 v156, v[96:99] offset:8320
    v_pk_mul_f32 v[100:101], v[100:101], v[12:13] op_sel:[0,1] op_sel_hi:[1,1]
    v_pk_fma_f32 v[100:101], v[220:221], v[160:161], v[100:101] op_sel:[0,1,0] op_sel_hi:[1,1,1]
    v_pk_mul_f32 v[102:103], v[102:103], v[12:13] op_sel:[0,1] op_sel_hi:[1,1]
    v_pk_fma_f32 v[102:103], v[222:223], v[160:161], v[102:103] op_sel:[0,1,0] op_sel_hi:[1,1,1]
    ds_write_b128 v157, v[100:103] offset:8320
    v_pk_mul_f32 v[104:105], v[104:105], v[12:13] op_sel:[0,1] op_sel_hi:[1,1]
    v_pk_fma_f32 v[104:105], v[224:225], v[160:161], v[104:105] op_sel:[0,1,0] op_sel_hi:[1,1,1]
    v_pk_mul_f32 v[106:107], v[106:107], v[12:13] op_sel:[0,1] op_sel_hi:[1,1]
    v_pk_fma_f32 v[106:107], v[226:227], v[160:161], v[106:107] op_sel:[0,1,0] op_sel_hi:[1,1,1]
    ds_write_b128 v158, v[104:107] offset:8320
    v_pk_mul_f32 v[108:109], v[108:109], v[12:13] op_sel:[0,1] op_sel_hi:[1,1]
    v_pk_fma_f32 v[108:109], v[228:229], v[160:161], v[108:109] op_sel:[0,1,0] op_sel_hi:[1,1,1]
    v_pk_mul_f32 v[110:111], v[110:111], v[12:13] op_sel:[0,1] op_sel_hi:[1,1]
    v_pk_fma_f32 v[110:111], v[230:231], v[160:161], v[110:111] op_sel:[0,1,0] op_sel_hi:[1,1,1]
    ds_write_b128 v159, v[108:111] offset:8320
    s_waitcnt lgkmcnt(0)
    s_barrier
    ds_read_b128 v[48:51], v5 offset:0
    ds_read_b128 v[52:55], v5 offset:32768
    ds_read_b128 v[56:59], v7 offset:0
    ds_read_b128 v[60:63], v7 offset:32768
    ds_read_b128 v[64:67], v6 offset:1024
    ds_read_b128 v[68:71], v6 offset:33792
    ds_read_b128 v[72:75], v8 offset:1024
    ds_read_b128 v[76:79], v8 offset:33792
    ds_read_b128 v[80:83], v5 offset:2048
    ds_read_b128 v[84:87], v5 offset:34816
    ds_read_b128 v[88:91], v7 offset:2048
    ds_read_b128 v[92:95], v7 offset:34816
    ds_read_b128 v[96:99], v6 offset:3072
    ds_read_b128 v[100:103], v6 offset:35840
    ds_read_b128 v[104:107], v8 offset:3072
    ds_read_b128 v[108:111], v8 offset:35840
    s_waitcnt lgkmcnt(14)
    v_pk_add_f32 v[48:49], v[48:49], v[52:53]
    s_waitcnt lgkmcnt(12)
    v_pk_add_f32 v[56:57], v[56:57], v[60:61]
    v_pk_add_f32 v[50:51], v[50:51], v[54:55]
    v_pk_add_f32 v[58:59], v[58:59], v[62:63]
    v_pk_add_f32 v[48:49], v[48:49], v[240:241]
    v_pk_add_f32 v[50:51], v[50:51], v[242:243]
    v_pk_add_f32 v[48:49], v[48:49], v[56:57]
    v_pk_add_f32 v[50:51], v[50:51], v[58:59]
    s_mov_b32 s87, 0
    buffer_store_dwordx4 v[48:51], v9, s[72:75], s87 offen sc1
    s_waitcnt lgkmcnt(10)
    v_pk_add_f32 v[64:65], v[64:65], v[68:69]
    s_waitcnt lgkmcnt(8)
    v_pk_add_f32 v[72:73], v[72:73], v[76:77]
    v_pk_add_f32 v[66:67], v[66:67], v[70:71]
    v_pk_add_f32 v[74:75], v[74:75], v[78:79]
    v_pk_add_f32 v[64:65], v[64:65], v[244:245]
    v_pk_add_f32 v[66:67], v[66:67], v[246:247]
    v_pk_add_f32 v[64:65], v[64:65], v[72:73]
    v_pk_add_f32 v[66:67], v[66:67], v[74:75]
    s_mov_b32 s87, 65536
    buffer_store_dwordx4 v[64:67], v9, s[72:75], s87 offen sc1
    s_waitcnt lgkmcnt(6)
    v_pk_add_f32 v[80:81], v[80:81], v[84:85]
    s_waitcnt lgkmcnt(4)
    v_pk_add_f32 v[88:89], v[88:89], v[92:93]
    v_pk_add_f32 v[82:83], v[82:83], v[86:87]
    v_pk_add_f32 v[90:91], v[90:91], v[94:95]
    v_pk_add_f32 v[80:81], v[80:81], v[248:249]
    v_pk_add_f32 v[82:83], v[82:83], v[250:251]
    v_pk_add_f32 v[80:81], v[80:81], v[88:89]
    v_pk_add_f32 v[82:83], v[82:83], v[90:91]
    s_mov_b32 s87, 4096
    buffer_store_dwordx4 v[80:83], v9, s[72:75], s87 offen sc1
    s_waitcnt lgkmcnt(2)
    v_pk_add_f32 v[96:97], v[96:97], v[100:101]
    s_waitcnt lgkmcnt(0)
    v_pk_add_f32 v[104:105], v[104:105], v[108:109]
    v_pk_add_f32 v[98:99], v[98:99], v[102:103]
    v_pk_add_f32 v[106:107], v[106:107], v[110:111]
    v_pk_add_f32 v[96:97], v[96:97], v[252:253]
    v_pk_add_f32 v[98:99], v[98:99], v[254:255]
    v_pk_add_f32 v[96:97], v[96:97], v[104:105]
    v_pk_add_f32 v[98:99], v[98:99], v[106:107]
    s_mov_b32 s87, 69632
    buffer_store_dwordx4 v[96:99], v9, s[72:75], s87 offen sc1
L_end:
    s_endpgm

.section .rodata,"a"
.p2align 6
.amdhsa_kernel gated_mix__ssm_conv_s5__dense_activation_mish__prompt_kernel
  .amdhsa_next_free_vgpr 512
  .amdhsa_next_free_sgpr 102
  .amdhsa_accum_offset 256
  .amdhsa_group_segment_fixed_size 0
  .amdhsa_kernarg_size 136
  .amdhsa_user_sgpr_count 2
  .amdhsa_user_sgpr_kernarg_segment_ptr 1
  .amdhsa_system_sgpr_workgroup_id_x 1
  .amdhsa_float_denorm_mode_32 3
.end_amdhsa_kernel
```
